```python
import torch

def _softmax(x, axis=-1):
    return torch.softmax(x, dim=axis)
def _gelu(x):
    return torch.nn.functional.gelu(x, approximate="tanh")
def _silu(x):
    return torch.nn.functional.silu(x)
def _sigmoid(x):
    return torch.sigmoid(x)
def _layernorm(x, axis=-1, eps=1e-5):
    m = x.mean(dim=axis, keepdim=True)
    v = x.var(dim=axis, keepdim=True, unbiased=False)
    return (x - m) / torch.sqrt(v + eps)
def _scatter_add(tgt, idx, src, axis=0):
    return tgt.clone().index_add_(axis, idx, src)
def _segment_sum(src, seg, n):
    out = torch.zeros((n,) + src.shape[1:], dtype=src.dtype)
    return out.index_add_(0, seg, src)
def _pad(x, pw):
    flat = tuple(v for pair in reversed(pw) for v in pair)
    return torch.nn.functional.pad(x, flat)

kernel_name = 'standalone__geglu_ffn__sampling'

def setup_inputs():

    _w = (lambda a: (lambda t: t.to(torch.bfloat16) if t.is_floating_point() else t)(torch.as_tensor(a)))
    B, S, D, F = 32, 32, 576, 4608
    return {
        "x": _w((lambda *s: torch.randn(*s, dtype=torch.bfloat16) * 0.05)(B, S, D)),
        "w_gate": _w((lambda *s: torch.randn(*s, dtype=torch.bfloat16) * 0.05)(D, F)),
        "w_up": _w((lambda *s: torch.randn(*s, dtype=torch.bfloat16) * 0.05)(D, F)),
        "w_down": _w((lambda *s: torch.randn(*s, dtype=torch.bfloat16) * 0.05)(F, D)),
    }

def reference(x, w_gate, w_up, w_down):
    return (_gelu(x @ w_gate) * (x @ w_up)) @ w_down
```

```asm
; @launch grid=(256,1,1) block=(512,1,1) lds=163840
.amdgcn_target "amdgcn-amd-amdhsa--gfx950"
.text
.globl standalone__geglu_ffn__sampling_kernel
.p2align 8
.type standalone__geglu_ffn__sampling_kernel,@function
standalone__geglu_ffn__sampling_kernel:
L_pc:
    s_cmp_ge_u32 s2, 256
    s_cbranch_scc1 L_end
    s_load_dwordx8 s[36:43], s[0:1], 0
    s_load_dwordx2 s[44:45], s[0:1], 32
    s_load_dwordx2 s[48:49], s[0:1], 48
    v_readfirstlane_b32 s3, v0
    v_and_b32 v0, 63, v0
    s_and_b32 s4, s2, 7
    s_lshr_b32 s5, s2, 5
    s_lshr_b32 s6, s2, 3
    s_and_b32 s6, s6, 3
    s_lshr_b32 s3, s3, 6
    s_cmp_ge_u32 s3, 4
    s_cbranch_scc1 L_load
    s_getpc_b64 s[32:33]
L_pc0:
    s_sub_u32 s32, s32, L_pc0-L_pc
    s_subb_u32 s33, s33, 0
    s_lshr_b32 s54, s2, 3
    s_lshl_b32 s54, s54, 2
    s_add_u32 s54, s54, s3
    s_lshl_b32 s54, s54, 7
    v_lshlrev_b32 v46, 14, v0
    v_add_u32 v46, s54, v46
    v_min_u32 v46, L_codeend-L_pc-4, v46
    s_mov_b64 exec, 7
    global_load_dword v47, v46, s[32:33]
    s_mov_b64 exec, -1
    s_branch L_mfma
L_load:
    s_setprio 2
    s_sub_u32 s62, s3, 4
    s_and_b32 s63, s62, 1
    s_add_u32 s7, s6, s5
    s_lshl_b32 s7, s7, 2
    s_mov_b32 s54, 0x30630630
    s_mov_b32 s55, 0x306
    s_lshr_b64 s[54:55], s[54:55], s7
    s_and_b32 s7, s54, 15
    s_add_u32 s7, s7, s4
    s_cmp_ge_u32 s7, 9
    s_cselect_b32 s54, 9, 0
    s_sub_u32 s7, s7, s54
    s_mov_b32 s46, s7
    v_lshrrev_b32 v16, 3, v0
    v_bfe_u32 v17, v0, 1, 2
    v_and_b32 v18, 1, v0
    v_lshlrev_b32 v18, 4, v18
    v_bfe_u32 v19, v0, 4, 1
    s_lshl_b32 s54, s63, 1
    v_or_b32 v19, s54, v19
    v_xor_b32 v19, v19, v17
    v_mul_u32_u24 v2, 9216, v16
    v_lshl_add_u32 v2, v19, 5, v2
    v_add_u32 v2, v2, v18
    v_and_b32 v19, 7, v0
    v_lshrrev_b32 v20, 4, v0
    v_xor_b32 v19, v19, v20
    s_lshl_b32 s54, s63, 2
    v_xor_b32 v19, s54, v19
    v_mul_u32_u24 v3, 1152, v16
    v_lshl_add_u32 v3, v19, 4, v3
    s_lshr_b32 s54, s62, 1
    s_lshl_b32 s58, s54, 13
    s_lshl_b32 s55, s63, 10
    s_add_u32 s58, s58, s55
    s_lshl_b32 s30, s62, 10
    s_lshl_b32 s31, s62, 12
    s_mul_i32 s60, s4, 1152
    s_lshl_b32 s61, s6, 8
    s_add_u32 s61, s61, s60
    s_mul_i32 s54, s63, 73728
    s_add_u32 s61, s61, s54
    s_lshl_b32 s28, s5, 4
    s_add_u32 s28, s28, s62
    s_mul_i32 s28, s28, 9216
    s_waitcnt lgkmcnt(0)
    s_mov_b32 s8, s36
    s_mov_b32 s9, s37
    s_mov_b32 s10, 1179648
    s_mov_b32 s11, 0x00020000
    s_cmp_ge_u32 s62, 2
    s_cselect_b32 s12, s40, s38
    s_cselect_b32 s13, s41, s39
    s_mov_b32 s14, 5308416
    s_mov_b32 s15, 0x00020000
    s_add_u32 m0, s58, 0
    s_mul_i32 s54, s7, 589824
    s_add_u32 s54, s54, s61
    buffer_load_dwordx4 v2, s[12:15], s54 offen lds
    s_add_u32 m0, s58, 2048
    s_add_u32 s54, s54, 147456
    buffer_load_dwordx4 v2, s[12:15], s54 offen lds
    s_add_u32 m0, s58, 4096
    s_add_u32 s54, s54, 147456
    buffer_load_dwordx4 v2, s[12:15], s54 offen lds
    s_add_u32 m0, s58, 6144
    s_add_u32 s54, s54, 147456
    buffer_load_dwordx4 v2, s[12:15], s54 offen lds
    s_add_u32 m0, s30, 65536
    s_lshl_b32 s54, s7, 7
    s_add_u32 s54, s54, s28
    buffer_load_dwordx4 v3, s[8:11], s54 offen lds
    s_add_u32 m0, s30, 69632
    s_add_u32 s54, s54, 36864
    buffer_load_dwordx4 v3, s[8:11], s54 offen lds
    s_add_u32 m0, s30, 73728
    s_add_u32 s54, s54, 36864
    buffer_load_dwordx4 v3, s[8:11], s54 offen lds
    s_add_u32 m0, s30, 77824
    s_add_u32 s54, s54, 36864
    buffer_load_dwordx4 v3, s[8:11], s54 offen lds
    s_add_u32 s7, s7, 1
    s_cmp_eq_u32 s7, 9
    s_cselect_b32 s7, 0, s7
    s_load_dword s64, s[48:49], 0
    s_add_u32 m0, s58, 16384
    s_mul_i32 s54, s7, 589824
    s_add_u32 s54, s54, s61
    buffer_load_dwordx4 v2, s[12:15], s54 offen lds
    s_add_u32 m0, s58, 18432
    s_add_u32 s54, s54, 147456
    buffer_load_dwordx4 v2, s[12:15], s54 offen lds
    s_add_u32 m0, s58, 20480
    s_add_u32 s54, s54, 147456
    buffer_load_dwordx4 v2, s[12:15], s54 offen lds
    s_add_u32 m0, s58, 22528
    s_add_u32 s54, s54, 147456
    buffer_load_dwordx4 v2, s[12:15], s54 offen lds
    s_add_u32 m0, s30, 81920
    s_lshl_b32 s54, s7, 7
    s_add_u32 s54, s54, s28
    buffer_load_dwordx4 v3, s[8:11], s54 offen lds
    s_add_u32 m0, s30, 86016
    s_add_u32 s54, s54, 36864
    buffer_load_dwordx4 v3, s[8:11], s54 offen lds
    s_add_u32 m0, s30, 90112
    s_add_u32 s54, s54, 36864
    buffer_load_dwordx4 v3, s[8:11], s54 offen lds
    s_add_u32 m0, s30, 94208
    s_add_u32 s54, s54, 36864
    buffer_load_dwordx4 v3, s[8:11], s54 offen lds
    s_add_u32 s7, s7, 1
    s_cmp_eq_u32 s7, 9
    s_cselect_b32 s7, 0, s7
    s_mov_b32 s16, s42
    s_mov_b32 s17, s43
    s_mov_b32 s18, 5308416
    s_mov_b32 s19, 0x00020000
    s_mov_b32 s24, s48
    s_mov_b32 s25, s49
    s_mov_b32 s26, 33554432
    s_mov_b32 s27, 0x00020000
    s_mul_i32 s29, s4, 663552
    v_mul_u32_u24 v19, 9216, v16
    v_and_b32 v20, 7, v0
    v_lshl_add_u32 v19, v20, 4, v19
    s_lshr_b32 s53, s2, 3
    s_lshl_b32 s53, s53, 1
    s_add_u32 s53, s53, s63
    s_mul_i32 s54, s53, 73728
    s_add_u32 s54, s54, s60
    s_add_u32 s54, s54, 1024
    buffer_load_dwordx4 v[24:27], v19, s[12:15], s54 offen
    s_add_u32 s54, s54, 4718592
    buffer_load_dwordx4 v[28:31], v19, s[12:15], s54 offen
    v_mul_u32_u24 v19, 1152, v16
    v_lshl_add_u32 v19, v20, 4, v19
    s_lshr_b32 s34, s2, 3
    s_lshl_b32 s34, s34, 2
    s_add_u32 s34, s34, s62
    s_sub_u32 s34, 127, s34
    s_mul_i32 s54, s34, 9216
    s_add_u32 s54, s54, s29
    s_add_u32 s54, s54, 1024
    s_cmp_lt_u32 s34, 72
    s_cselect_b32 s54, s54, 5308416
    buffer_load_dwordx4 v[12:15], v19, s[16:19], s54 offen
    s_waitcnt lgkmcnt(0)
    s_add_u32 s64, s64, 0x9e3779b9
    s_waitcnt vmcnt(11)
    s_barrier
    s_mov_b32 s20, s44
    s_mov_b32 s21, s45
    s_mov_b32 s22, 1179648
    s_mov_b32 s23, 0x00020000
    v_lshrrev_b32 v19, 4, v0
    v_xor_b32 v19, v19, v17
    v_mul_u32_u24 v5, 1152, v16
    v_lshl_add_u32 v5, v19, 5, v5
    v_add_u32 v5, v5, v18
    v_lshlrev_b32 v6, 4, v0
    v_lshlrev_b32 v7, 15, v0
    v_lshlrev_b32 v8, 2, v0
    s_lshl_b32 s47, s4, 2
    s_add_u32 s47, s47, s6
    s_mul_i32 s59, s47, 18432
    s_add_u32 s59, s59, 3145728
    s_mul_i32 s47, s47, 36864
    s_add_u32 s47, s47, s30
    s_add_u32 s47, s47, 1114112
    s_lshl_b32 s35, s6, 8
    s_add_u32 s35, s35, s29
    s_mov_b32 s52, s35
    s_lshr_b32 s54, s62, 1
    s_lshl_b32 s54, s54, 7
    s_add_u32 s35, s35, s54
    s_and_b32 s32, s2, 0xe7
    s_lshl_b32 s32, s32, 12
    s_add_u32 s32, s32, 4096
    s_lshl_b32 s44, s4, 12
    s_add_u32 s44, s44, 5632
    s_cmp_eq_u32 s62, 3
    s_cselect_b32 s44, s44, 33554432
    s_lshl_b32 s33, s2, 12
    s_add_u32 s33, s33, 4096
    s_cmp_eq_u32 s62, 0
    s_cselect_b32 s33, s33, 33554432
    s_add_u32 m0, s58, 32768
    s_mul_i32 s54, s7, 589824
    s_add_u32 s54, s54, s61
    buffer_load_dwordx4 v2, s[12:15], s54 offen lds
    s_add_u32 m0, s58, 34816
    s_add_u32 s54, s54, 147456
    buffer_load_dwordx4 v2, s[12:15], s54 offen lds
    s_add_u32 m0, s58, 36864
    s_add_u32 s54, s54, 147456
    buffer_load_dwordx4 v2, s[12:15], s54 offen lds
    s_add_u32 m0, s58, 38912
    s_add_u32 s54, s54, 147456
    buffer_load_dwordx4 v2, s[12:15], s54 offen lds
    s_add_u32 m0, s30, 98304
    s_lshl_b32 s54, s7, 7
    s_add_u32 s54, s54, s28
    buffer_load_dwordx4 v3, s[8:11], s54 offen lds
    s_add_u32 m0, s30, 102400
    s_add_u32 s54, s54, 36864
    buffer_load_dwordx4 v3, s[8:11], s54 offen lds
    s_add_u32 m0, s30, 106496
    s_add_u32 s54, s54, 36864
    buffer_load_dwordx4 v3, s[8:11], s54 offen lds
    s_add_u32 m0, s30, 110592
    s_add_u32 s54, s54, 36864
    buffer_load_dwordx4 v3, s[8:11], s54 offen lds
    s_add_u32 s7, s7, 1
    s_cmp_eq_u32 s7, 9
    s_cselect_b32 s7, 0, s7
    s_cmp_lg_u32 s62, 1
    s_cbranch_scc1 L_nt1
    s_call_b64 s[50:51], L_pad1
L_nt1:
    s_waitcnt vmcnt(11)
    s_barrier
    s_add_u32 m0, s58, 49152
    s_mul_i32 s54, s7, 589824
    s_add_u32 s54, s54, s61
    buffer_load_dwordx4 v2, s[12:15], s54 offen lds
    s_add_u32 m0, s58, 51200
    s_add_u32 s54, s54, 147456
    buffer_load_dwordx4 v2, s[12:15], s54 offen lds
    s_add_u32 m0, s58, 53248
    s_add_u32 s54, s54, 147456
    buffer_load_dwordx4 v2, s[12:15], s54 offen lds
    s_add_u32 m0, s58, 55296
    s_add_u32 s54, s54, 147456
    buffer_load_dwordx4 v2, s[12:15], s54 offen lds
    s_add_u32 m0, s30, 114688
    s_lshl_b32 s54, s7, 7
    s_add_u32 s54, s54, s28
    buffer_load_dwordx4 v3, s[8:11], s54 offen lds
    s_add_u32 m0, s30, 118784
    s_add_u32 s54, s54, 36864
    buffer_load_dwordx4 v3, s[8:11], s54 offen lds
    s_add_u32 m0, s30, 122880
    s_add_u32 s54, s54, 36864
    buffer_load_dwordx4 v3, s[8:11], s54 offen lds
    s_add_u32 m0, s30, 126976
    s_add_u32 s54, s54, 36864
    buffer_load_dwordx4 v3, s[8:11], s54 offen lds
    s_add_u32 s7, s7, 1
    s_cmp_eq_u32 s7, 9
    s_cselect_b32 s7, 0, s7
    s_waitcnt vmcnt(8)
    s_barrier
    s_add_u32 m0, s58, 0
    s_mul_i32 s54, s7, 589824
    s_add_u32 s54, s54, s61
    buffer_load_dwordx4 v2, s[12:15], s54 offen lds
    s_add_u32 m0, s58, 2048
    s_add_u32 s54, s54, 147456
    buffer_load_dwordx4 v2, s[12:15], s54 offen lds
    s_add_u32 m0, s58, 4096
    s_add_u32 s54, s54, 147456
    buffer_load_dwordx4 v2, s[12:15], s54 offen lds
    s_add_u32 m0, s58, 6144
    s_add_u32 s54, s54, 147456
    buffer_load_dwordx4 v2, s[12:15], s54 offen lds
    s_add_u32 m0, s30, 65536
    s_lshl_b32 s54, s7, 7
    s_add_u32 s54, s54, s28
    buffer_load_dwordx4 v3, s[8:11], s54 offen lds
    s_add_u32 m0, s30, 69632
    s_add_u32 s54, s54, 36864
    buffer_load_dwordx4 v3, s[8:11], s54 offen lds
    s_add_u32 m0, s30, 73728
    s_add_u32 s54, s54, 36864
    buffer_load_dwordx4 v3, s[8:11], s54 offen lds
    s_add_u32 m0, s30, 77824
    s_add_u32 s54, s54, 36864
    buffer_load_dwordx4 v3, s[8:11], s54 offen lds
    s_add_u32 s7, s7, 1
    s_cmp_eq_u32 s7, 9
    s_cselect_b32 s7, 0, s7
    s_waitcnt vmcnt(8)
    s_barrier
    s_add_u32 m0, s58, 16384
    s_mul_i32 s54, s7, 589824
    s_add_u32 s54, s54, s61
    buffer_load_dwordx4 v2, s[12:15], s54 offen lds
    s_add_u32 m0, s58, 18432
    s_add_u32 s54, s54, 147456
    buffer_load_dwordx4 v2, s[12:15], s54 offen lds
    s_add_u32 m0, s58, 20480
    s_add_u32 s54, s54, 147456
    buffer_load_dwordx4 v2, s[12:15], s54 offen lds
    s_add_u32 m0, s58, 22528
    s_add_u32 s54, s54, 147456
    buffer_load_dwordx4 v2, s[12:15], s54 offen lds
    s_add_u32 m0, s30, 81920
    s_lshl_b32 s54, s7, 7
    s_add_u32 s54, s54, s28
    buffer_load_dwordx4 v3, s[8:11], s54 offen lds
    s_add_u32 m0, s30, 86016
    s_add_u32 s54, s54, 36864
    buffer_load_dwordx4 v3, s[8:11], s54 offen lds
    s_add_u32 m0, s30, 90112
    s_add_u32 s54, s54, 36864
    buffer_load_dwordx4 v3, s[8:11], s54 offen lds
    s_add_u32 m0, s30, 94208
    s_add_u32 s54, s54, 36864
    buffer_load_dwordx4 v3, s[8:11], s54 offen lds
    s_add_u32 s7, s7, 1
    s_cmp_eq_u32 s7, 9
    s_cselect_b32 s7, 0, s7
    s_waitcnt vmcnt(8)
    s_barrier
    s_add_u32 m0, s58, 32768
    s_mul_i32 s54, s7, 589824
    s_add_u32 s54, s54, s61
    buffer_load_dwordx4 v2, s[12:15], s54 offen lds
    s_add_u32 m0, s58, 34816
    s_add_u32 s54, s54, 147456
    buffer_load_dwordx4 v2, s[12:15], s54 offen lds
    s_add_u32 m0, s58, 36864
    s_add_u32 s54, s54, 147456
    buffer_load_dwordx4 v2, s[12:15], s54 offen lds
    s_add_u32 m0, s58, 38912
    s_add_u32 s54, s54, 147456
    buffer_load_dwordx4 v2, s[12:15], s54 offen lds
    s_add_u32 m0, s30, 98304
    s_lshl_b32 s54, s7, 7
    s_add_u32 s54, s54, s28
    buffer_load_dwordx4 v3, s[8:11], s54 offen lds
    s_add_u32 m0, s30, 102400
    s_add_u32 s54, s54, 36864
    buffer_load_dwordx4 v3, s[8:11], s54 offen lds
    s_add_u32 m0, s30, 106496
    s_add_u32 s54, s54, 36864
    buffer_load_dwordx4 v3, s[8:11], s54 offen lds
    s_add_u32 m0, s30, 110592
    s_add_u32 s54, s54, 36864
    buffer_load_dwordx4 v3, s[8:11], s54 offen lds
    s_add_u32 s7, s7, 1
    s_cmp_eq_u32 s7, 9
    s_cselect_b32 s7, 0, s7
    s_waitcnt vmcnt(8)
    s_barrier
    s_add_u32 m0, s58, 49152
    s_mul_i32 s54, s7, 589824
    s_add_u32 s54, s54, s61
    buffer_load_dwordx4 v2, s[12:15], s54 offen lds
    s_add_u32 m0, s58, 51200
    s_add_u32 s54, s54, 147456
    buffer_load_dwordx4 v2, s[12:15], s54 offen lds
    s_add_u32 m0, s58, 53248
    s_add_u32 s54, s54, 147456
    buffer_load_dwordx4 v2, s[12:15], s54 offen lds
    s_add_u32 m0, s58, 55296
    s_add_u32 s54, s54, 147456
    buffer_load_dwordx4 v2, s[12:15], s54 offen lds
    s_add_u32 m0, s30, 114688
    s_lshl_b32 s54, s7, 7
    s_add_u32 s54, s54, s28
    buffer_load_dwordx4 v3, s[8:11], s54 offen lds
    s_add_u32 m0, s30, 118784
    s_add_u32 s54, s54, 36864
    buffer_load_dwordx4 v3, s[8:11], s54 offen lds
    s_add_u32 m0, s30, 122880
    s_add_u32 s54, s54, 36864
    buffer_load_dwordx4 v3, s[8:11], s54 offen lds
    s_add_u32 m0, s30, 126976
    s_add_u32 s54, s54, 36864
    buffer_load_dwordx4 v3, s[8:11], s54 offen lds
    s_add_u32 s7, s7, 1
    s_cmp_eq_u32 s7, 9
    s_cselect_b32 s7, 0, s7
    s_waitcnt vmcnt(8)
    s_barrier
    s_add_u32 m0, s58, 0
    s_mul_i32 s54, s7, 589824
    s_add_u32 s54, s54, s61
    buffer_load_dwordx4 v2, s[12:15], s54 offen lds
    s_add_u32 m0, s58, 2048
    s_add_u32 s54, s54, 147456
    buffer_load_dwordx4 v2, s[12:15], s54 offen lds
    s_add_u32 m0, s58, 4096
    s_add_u32 s54, s54, 147456
    buffer_load_dwordx4 v2, s[12:15], s54 offen lds
    s_add_u32 m0, s58, 6144
    s_add_u32 s54, s54, 147456
    buffer_load_dwordx4 v2, s[12:15], s54 offen lds
    s_add_u32 m0, s30, 65536
    s_lshl_b32 s54, s7, 7
    s_add_u32 s54, s54, s28
    buffer_load_dwordx4 v3, s[8:11], s54 offen lds
    s_add_u32 m0, s30, 69632
    s_add_u32 s54, s54, 36864
    buffer_load_dwordx4 v3, s[8:11], s54 offen lds
    s_add_u32 m0, s30, 73728
    s_add_u32 s54, s54, 36864
    buffer_load_dwordx4 v3, s[8:11], s54 offen lds
    s_add_u32 m0, s30, 77824
    s_add_u32 s54, s54, 36864
    buffer_load_dwordx4 v3, s[8:11], s54 offen lds
    s_add_u32 s7, s7, 1
    s_cmp_eq_u32 s7, 9
    s_cselect_b32 s7, 0, s7
    s_waitcnt vmcnt(8)
    s_barrier
    s_add_u32 m0, s58, 131072
    s_add_u32 s61, s61, 128
    s_branch L_skiplpad1
.p2align 12
L_lpad1:
    s_setpc_b64 s[50:51]
L_skiplpad1:
    s_mul_i32 s54, s7, 589824
    s_add_u32 s54, s54, s61
    buffer_load_dwordx4 v2, s[12:15], s54 offen lds
    s_add_u32 m0, s58, 133120
    s_add_u32 s54, s54, 147456
    buffer_load_dwordx4 v2, s[12:15], s54 offen lds
    s_add_u32 m0, s58, 135168
    s_add_u32 s54, s54, 147456
    buffer_load_dwordx4 v2, s[12:15], s54 offen lds
    s_add_u32 m0, s58, 137216
    s_add_u32 s54, s54, 147456
    buffer_load_dwordx4 v2, s[12:15], s54 offen lds
    s_add_u32 s7, s7, 1
    s_cmp_eq_u32 s7, 9
    s_cselect_b32 s7, 0, s7
    s_add_u32 m0, s58, 147456
    s_mul_i32 s54, s7, 589824
    s_add_u32 s54, s54, s61
    buffer_load_dwordx4 v2, s[12:15], s54 offen lds
    s_add_u32 m0, s58, 149504
    s_add_u32 s54, s54, 147456
    buffer_load_dwordx4 v2, s[12:15], s54 offen lds
    s_add_u32 m0, s58, 151552
    s_add_u32 s54, s54, 147456
    buffer_load_dwordx4 v2, s[12:15], s54 offen lds
    s_add_u32 m0, s58, 153600
    s_add_u32 s54, s54, 147456
    buffer_load_dwordx4 v2, s[12:15], s54 offen lds
    s_add_u32 s7, s7, 1
    s_cmp_eq_u32 s7, 9
    s_cselect_b32 s7, 0, s7
    s_waitcnt vmcnt(8)
    s_barrier
    s_lshl_b32 s54, s63, 2
    v_xor_b32 v19, s54, v16
    v_lshlrev_b32 v19, 5, v19
    v_add_u32 v19, v19, v18
    v_mul_u32_u24 v20, 36864, v17
    v_add_u32 v19, v19, v20
    s_lshr_b32 s54, s53, 3
    s_lshl_b32 s54, s54, 12
    s_and_b32 s55, s53, 7
    s_lshl_b32 s55, s55, 8
    s_add_u32 s54, s54, s55
    s_lshr_b32 s55, s62, 1
    s_lshl_b32 s55, s55, 11
    s_add_u32 s54, s54, s55
    s_mul_i32 s55, s4, 147456
    s_add_u32 s54, s54, s55
    s_add_u32 s54, s54, 1114112
    buffer_store_dwordx4 v[24:27], v19, s[24:27], s54 offen sc1
    s_add_u32 s54, s54, 32768
    s_cmp_lt_u32 s53, 8
    s_cselect_b32 s54, s54, 33554432
    buffer_store_dwordx4 v[28:31], v19, s[24:27], s54 offen sc1
    v_lshl_add_u32 v19, v16, 5, v18
    v_mul_u32_u24 v20, 18432, v17
    v_add_u32 v19, v19, v20
    s_lshl_b32 s54, s34, 8
    s_mul_i32 s55, s4, 73728
    s_add_u32 s54, s54, s55
    s_add_u32 s54, s54, 3145728
    s_cmp_lt_u32 s34, 72
    s_cselect_b32 s54, s54, 33554432
    buffer_store_dwordx4 v[12:15], v19, s[24:27], s54 offen sc1
    s_add_u32 m0, s58, 16384
    s_mul_i32 s54, s7, 589824
    s_add_u32 s54, s54, s61
    buffer_load_dwordx4 v2, s[12:15], s54 offen lds
    s_add_u32 m0, s58, 18432
    s_add_u32 s54, s54, 147456
    buffer_load_dwordx4 v2, s[12:15], s54 offen lds
    s_add_u32 m0, s58, 20480
    s_add_u32 s54, s54, 147456
    buffer_load_dwordx4 v2, s[12:15], s54 offen lds
    s_add_u32 m0, s58, 22528
    s_add_u32 s54, s54, 147456
    buffer_load_dwordx4 v2, s[12:15], s54 offen lds
    s_add_u32 s7, s7, 1
    s_cmp_eq_u32 s7, 9
    s_cselect_b32 s7, 0, s7
    s_add_u32 m0, s58, 81920
    s_mul_i32 s54, s7, 589824
    s_add_u32 s54, s54, s61
    buffer_load_dwordx4 v2, s[12:15], s54 offen lds
    s_add_u32 m0, s58, 83968
    s_add_u32 s54, s54, 147456
    buffer_load_dwordx4 v2, s[12:15], s54 offen lds
    s_add_u32 m0, s58, 86016
    s_add_u32 s54, s54, 147456
    buffer_load_dwordx4 v2, s[12:15], s54 offen lds
    s_add_u32 m0, s58, 88064
    s_add_u32 s54, s54, 147456
    buffer_load_dwordx4 v2, s[12:15], s54 offen lds
    s_add_u32 s7, s7, 1
    s_cmp_eq_u32 s7, 9
    s_cselect_b32 s7, 0, s7
    s_lshr_b32 s54, s2, 3
    s_lshl_b32 s54, s54, 2
    s_add_u32 s54, s54, s62
    s_mul_i32 s54, s54, 5184
    s_add_u32 s54, s54, s29
    v_lshlrev_b32 v19, 7, v0
    s_mov_b32 exec_hi, 0x1ff
    buffer_load_dword v21, v19, s[16:19], s54 offen
    s_mov_b64 exec, -1
    s_waitcnt vmcnt(16)
    s_barrier
    s_waitcnt vmcnt(9)
    s_cmp_lg_u32 s62, 1
    s_cbranch_scc1 L_nt2
    s_call_b64 s[50:51], L_pad2
L_nt2:
    s_cmp_lg_u32 s62, 1
    s_cbranch_scc1 L_nt3
    s_call_b64 s[50:51], L_pad3
L_nt3:
    s_barrier
    v_mov_b32 v22, s64
    s_mov_b64 exec, 0xffffffff
    buffer_store_dword v22, v8, s[24:27], s33 offen offset:1536 sc1
    s_mov_b64 exec, -1
    s_waitcnt vmcnt(6)
    s_barrier
    s_add_u32 m0, s58, 32768
    s_mul_i32 s54, s7, 589824
    s_add_u32 s54, s54, s61
    buffer_load_dwordx4 v2, s[12:15], s54 offen lds
    s_add_u32 m0, s58, 34816
    s_add_u32 s54, s54, 147456
    buffer_load_dwordx4 v2, s[12:15], s54 offen lds
    s_add_u32 m0, s58, 36864
    s_add_u32 s54, s54, 147456
    buffer_load_dwordx4 v2, s[12:15], s54 offen lds
    s_add_u32 m0, s58, 38912
    s_add_u32 s54, s54, 147456
    buffer_load_dwordx4 v2, s[12:15], s54 offen lds
    s_add_u32 s7, s7, 1
    s_cmp_eq_u32 s7, 9
    s_cselect_b32 s7, 0, s7
    s_waitcnt vmcnt(6)
    s_barrier
    s_add_u32 m0, s58, 98304
    s_mul_i32 s54, s7, 589824
    s_add_u32 s54, s54, s61
    buffer_load_dwordx4 v2, s[12:15], s54 offen lds
    s_add_u32 m0, s58, 100352
    s_add_u32 s54, s54, 147456
    buffer_load_dwordx4 v2, s[12:15], s54 offen lds
    s_add_u32 m0, s58, 102400
    s_add_u32 s54, s54, 147456
    buffer_load_dwordx4 v2, s[12:15], s54 offen lds
    s_add_u32 m0, s58, 104448
    s_add_u32 s54, s54, 147456
    buffer_load_dwordx4 v2, s[12:15], s54 offen lds
    s_add_u32 s7, s7, 1
    s_cmp_eq_u32 s7, 9
    s_cselect_b32 s7, 0, s7
    s_waitcnt vmcnt(4)
    s_barrier
    s_add_u32 m0, s58, 49152
    s_mul_i32 s54, s7, 589824
    s_add_u32 s54, s54, s61
    buffer_load_dwordx4 v2, s[12:15], s54 offen lds
    s_add_u32 m0, s58, 51200
    s_add_u32 s54, s54, 147456
    buffer_load_dwordx4 v2, s[12:15], s54 offen lds
    s_add_u32 m0, s58, 53248
    s_add_u32 s54, s54, 147456
    buffer_load_dwordx4 v2, s[12:15], s54 offen lds
    s_add_u32 m0, s58, 55296
    s_add_u32 s54, s54, 147456
    buffer_load_dwordx4 v2, s[12:15], s54 offen lds
    s_add_u32 s7, s7, 1
    s_cmp_eq_u32 s7, 9
    s_cselect_b32 s7, 0, s7
    s_add_u32 m0, s31, 65536
    s_add_u32 s54, s6, 0
    s_and_b32 s54, s54, 3
    s_lshl_b32 s54, s54, 2
    s_add_u32 s54, s54, 0
    s_add_u32 s54, s54, s63
    s_mul_i32 s54, s54, 36864
    s_add_u32 s54, s54, s35
    buffer_load_dwordx4 v5, s[16:19], s54 offen lds
    s_add_u32 m0, s31, 66560
    s_add_u32 s54, s54, 9216
    buffer_load_dwordx4 v5, s[16:19], s54 offen lds
    s_add_u32 m0, s31, 67584
    s_add_u32 s54, s54, 9216
    buffer_load_dwordx4 v5, s[16:19], s54 offen lds
    s_add_u32 m0, s31, 68608
    s_add_u32 s54, s54, 9216
    buffer_load_dwordx4 v5, s[16:19], s54 offen lds
    s_waitcnt vmcnt(8)
    s_barrier
    v_mov_b32 v22, s64
    s_mov_b64 exec, 0xffffffff
    buffer_store_dword v22, v8, s[24:27], s33 offen offset:0 sc1
    s_mov_b64 exec, -1
    s_add_u32 m0, s58, 114688
    s_mul_i32 s54, s7, 589824
    s_add_u32 s54, s54, s61
    buffer_load_dwordx4 v2, s[12:15], s54 offen lds
    s_add_u32 m0, s58, 116736
    s_add_u32 s54, s54, 147456
    buffer_load_dwordx4 v2, s[12:15], s54 offen lds
    s_add_u32 m0, s58, 118784
    s_add_u32 s54, s54, 147456
    buffer_load_dwordx4 v2, s[12:15], s54 offen lds
    s_add_u32 m0, s58, 120832
    s_add_u32 s54, s54, 147456
    buffer_load_dwordx4 v2, s[12:15], s54 offen lds
    s_add_u32 s7, s7, 1
    s_cmp_eq_u32 s7, 9
    s_cselect_b32 s7, 0, s7
    s_waitcnt vmcnt(9)
    s_barrier
    s_add_u32 m0, s58, 0
    s_mul_i32 s54, s7, 589824
    s_add_u32 s54, s54, s61
    buffer_load_dwordx4 v2, s[12:15], s54 offen lds
    s_add_u32 m0, s58, 2048
    s_add_u32 s54, s54, 147456
    buffer_load_dwordx4 v2, s[12:15], s54 offen lds
    s_add_u32 m0, s58, 4096
    s_add_u32 s54, s54, 147456
    buffer_load_dwordx4 v2, s[12:15], s54 offen lds
    s_add_u32 m0, s58, 6144
    s_add_u32 s54, s54, 147456
    buffer_load_dwordx4 v2, s[12:15], s54 offen lds
    s_add_u32 s7, s7, 1
    s_cmp_eq_u32 s7, 9
    s_cselect_b32 s7, 0, s7
    s_add_u32 m0, s31, 131072
    s_add_u32 s54, s6, 0
    s_and_b32 s54, s54, 3
    s_lshl_b32 s54, s54, 2
    s_add_u32 s54, s54, 2
    s_add_u32 s54, s54, s63
    s_mul_i32 s54, s54, 36864
    s_add_u32 s54, s54, s35
    buffer_load_dwordx4 v5, s[16:19], s54 offen lds
    s_add_u32 m0, s31, 132096
    s_add_u32 s54, s54, 9216
    buffer_load_dwordx4 v5, s[16:19], s54 offen lds
    s_add_u32 m0, s31, 133120
    s_add_u32 s54, s54, 9216
    buffer_load_dwordx4 v5, s[16:19], s54 offen lds
    s_add_u32 m0, s31, 134144
    s_add_u32 s54, s54, 9216
    buffer_load_dwordx4 v5, s[16:19], s54 offen lds
    s_mov_b32 s55, s44
    s_mov_b64 exec, 0xffffffff
    buffer_load_dword v23, v7, s[24:27], s55 offen sc1
    s_mov_b64 exec, -1
    s_waitcnt vmcnt(9)
    s_barrier
    s_add_u32 m0, s31, 147456
    s_add_u32 s54, s6, 1
    s_and_b32 s54, s54, 3
    s_lshl_b32 s54, s54, 2
    s_add_u32 s54, s54, 0
    s_add_u32 s54, s54, s63
    s_mul_i32 s54, s54, 36864
    s_add_u32 s54, s54, s35
    buffer_load_dwordx4 v5, s[16:19], s54 offen lds
    s_add_u32 m0, s31, 148480
    s_add_u32 s54, s54, 9216
    buffer_load_dwordx4 v5, s[16:19], s54 offen lds
    s_add_u32 m0, s31, 149504
    s_add_u32 s54, s54, 9216
    buffer_load_dwordx4 v5, s[16:19], s54 offen lds
    s_add_u32 m0, s31, 150528
    s_add_u32 s54, s54, 9216
    buffer_load_dwordx4 v5, s[16:19], s54 offen lds
    s_waitcnt vmcnt(4)
    s_cmp_lg_u32 s62, 3
    s_cbranch_scc1 L_pcont3
    s_mov_b64 exec, 0xffffffff
    v_cmp_ne_u32 vcc, s64, v23
    s_cbranch_vccnz L_pslow3
L_pcont3:
    s_mov_b64 exec, -1
    s_barrier
    s_add_u32 s55, s32, 0
    s_mov_b64 exec, 0xf
    buffer_load_dword v23, v7, s[24:27], s55 offen sc1
    s_mov_b64 exec, -1
    s_add_u32 m0, s30, 32768
    s_lshl_b32 s54, s46, 12
    s_add_u32 s54, s54, s47
    s_add_u32 s46, s46, 1
    s_cmp_eq_u32 s46, 9
    s_cselect_b32 s46, 0, s46
    buffer_load_dwordx4 v6, s[24:27], s54 offen sc1 lds
    s_add_u32 m0, s30, 36864
    s_lshl_b32 s54, s46, 12
    s_add_u32 s54, s54, s47
    s_add_u32 s46, s46, 1
    s_cmp_eq_u32 s46, 9
    s_cselect_b32 s46, 0, s46
    buffer_load_dwordx4 v6, s[24:27], s54 offen sc1 lds
    s_add_u32 m0, s30, 40960
    s_lshl_b32 s54, s46, 12
    s_add_u32 s54, s54, s47
    s_add_u32 s46, s46, 1
    s_cmp_eq_u32 s46, 9
    s_cselect_b32 s46, 0, s46
    buffer_load_dwordx4 v6, s[24:27], s54 offen sc1 lds
    s_add_u32 m0, s30, 98304
    s_lshl_b32 s54, s46, 12
    s_add_u32 s54, s54, s47
    s_add_u32 s46, s46, 1
    s_cmp_eq_u32 s46, 9
    s_cselect_b32 s46, 0, s46
    buffer_load_dwordx4 v6, s[24:27], s54 offen sc1 lds
    s_add_u32 m0, s30, 102400
    s_lshl_b32 s54, s46, 12
    s_add_u32 s54, s54, s47
    s_add_u32 s46, s46, 1
    s_cmp_eq_u32 s46, 9
    s_cselect_b32 s46, 0, s46
    buffer_load_dwordx4 v6, s[24:27], s54 offen sc1 lds
    s_add_u32 m0, s30, 106496
    s_lshl_b32 s54, s46, 12
    s_add_u32 s54, s54, s47
    s_add_u32 s46, s46, 1
    s_cmp_eq_u32 s46, 9
    s_cselect_b32 s46, 0, s46
    buffer_load_dwordx4 v6, s[24:27], s54 offen sc1 lds
    s_add_u32 m0, s30, 49152
    s_lshl_b32 s54, s46, 12
    s_add_u32 s54, s54, s47
    s_add_u32 s46, s46, 1
    s_cmp_eq_u32 s46, 9
    s_cselect_b32 s46, 0, s46
    buffer_load_dwordx4 v6, s[24:27], s54 offen sc1 lds
    s_add_u32 m0, s30, 53248
    s_lshl_b32 s54, s46, 12
    s_add_u32 s54, s54, s47
    s_add_u32 s46, s46, 1
    s_cmp_eq_u32 s46, 9
    s_cselect_b32 s46, 0, s46
    buffer_load_dwordx4 v6, s[24:27], s54 offen sc1 lds
    s_add_u32 m0, s30, 57344
    s_lshl_b32 s54, s46, 12
    s_add_u32 s54, s54, s47
    s_add_u32 s46, s46, 1
    s_cmp_eq_u32 s46, 9
    s_cselect_b32 s46, 0, s46
    buffer_load_dwordx4 v6, s[24:27], s54 offen sc1 lds
    s_add_u32 m0, s31, 16384
    s_lshl_b32 s54, s62, 3
    s_add_u32 s54, s54, 0
    s_lshr_b32 s54, 0x75364210, s54
    s_lshl_b32 s55, s6, 1
    s_add_u32 s54, s54, s55
    s_and_b32 s54, s54, 7
    s_lshl_b32 s54, s54, 11
    s_add_u32 s54, s54, s59
    buffer_load_dwordx4 v6, s[24:27], s54 offen sc1 lds
    s_add_u32 m0, s31, 17408
    s_add_u32 s54, s54, 1024
    buffer_load_dwordx4 v6, s[24:27], s54 offen sc1 lds
    s_add_u32 m0, s31, 18432
    s_lshl_b32 s54, s62, 3
    s_add_u32 s54, s54, 4
    s_lshr_b32 s54, 0x75364210, s54
    s_lshl_b32 s55, s6, 1
    s_add_u32 s54, s54, s55
    s_and_b32 s54, s54, 7
    s_lshl_b32 s54, s54, 11
    s_add_u32 s54, s54, s59
    buffer_load_dwordx4 v6, s[24:27], s54 offen sc1 lds
    s_add_u32 m0, s31, 19456
    s_add_u32 s54, s54, 1024
    buffer_load_dwordx4 v6, s[24:27], s54 offen sc1 lds
    s_cmp_lg_u32 s62, 1
    s_cbranch_scc1 L_nt4
    s_call_b64 s[50:51], L_pad4
L_nt4:
    s_cmp_lg_u32 s62, 1
    s_cbranch_scc1 L_nt5
    s_call_b64 s[50:51], L_pad5
L_nt5:
    s_waitcnt vmcnt(10)
    s_barrier
    s_mov_b64 exec, 0xf
    v_cmp_ne_u32 vcc, s64, v23
    s_cbranch_vccnz L_pslow0
L_pcont0:
    s_mov_b64 exec, -1
    s_add_u32 m0, s31, 81920
    s_add_u32 s55, s6, 1
    s_and_b32 s55, s55, 3
    s_lshl_b32 s55, s55, 3
    s_and_b32 s54, s2, 0xe7
    s_or_b32 s55, s55, s54
    s_lshl_b32 s54, s55, 15
    s_add_u32 s54, s54, s30
    s_add_u32 s54, s54, 4194304
    buffer_load_dwordx4 v6, s[24:27], s54 offen sc1 lds
    s_add_u32 m0, s31, 82944
    s_add_u32 s54, s54, 4096
    buffer_load_dwordx4 v6, s[24:27], s54 offen sc1 lds
    s_add_u32 m0, s31, 83968
    s_add_u32 s54, s54, 4096
    buffer_load_dwordx4 v6, s[24:27], s54 offen sc1 lds
    s_add_u32 m0, s31, 84992
    s_add_u32 s54, s54, 4096
    buffer_load_dwordx4 v6, s[24:27], s54 offen sc1 lds
    s_waitcnt vmcnt(11)
    s_barrier
    s_add_u32 m0, s31, 114688
    s_add_u32 s55, s6, 2
    s_and_b32 s55, s55, 3
    s_lshl_b32 s55, s55, 3
    s_and_b32 s54, s2, 0xe7
    s_or_b32 s55, s55, s54
    s_lshl_b32 s54, s55, 15
    s_add_u32 s54, s54, s30
    s_add_u32 s54, s54, 4194304
    buffer_load_dwordx4 v6, s[24:27], s54 offen sc1 lds
    s_add_u32 m0, s31, 115712
    s_add_u32 s54, s54, 4096
    buffer_load_dwordx4 v6, s[24:27], s54 offen sc1 lds
    s_add_u32 m0, s31, 116736
    s_add_u32 s54, s54, 4096
    buffer_load_dwordx4 v6, s[24:27], s54 offen sc1 lds
    s_add_u32 m0, s31, 117760
    s_add_u32 s54, s54, 4096
    buffer_load_dwordx4 v6, s[24:27], s54 offen sc1 lds
    s_add_u32 m0, s31, 0
    s_add_u32 s55, s6, 3
    s_and_b32 s55, s55, 3
    s_lshl_b32 s55, s55, 3
    s_and_b32 s54, s2, 0xe7
    s_or_b32 s55, s55, s54
    s_lshl_b32 s54, s55, 15
    s_add_u32 s54, s54, s30
    s_add_u32 s54, s54, 4194304
    buffer_load_dwordx4 v6, s[24:27], s54 offen sc1 lds
    s_add_u32 m0, s31, 1024
    s_add_u32 s54, s54, 4096
    buffer_load_dwordx4 v6, s[24:27], s54 offen sc1 lds
    s_add_u32 m0, s31, 2048
    s_add_u32 s54, s54, 4096
    buffer_load_dwordx4 v6, s[24:27], s54 offen sc1 lds
    s_add_u32 m0, s31, 3072
    s_add_u32 s54, s54, 4096
    buffer_load_dwordx4 v6, s[24:27], s54 offen sc1 lds
    s_waitcnt vmcnt(16)
    s_barrier
    v_mov_b32 v22, s64
    s_mov_b64 exec, 0xffffffff
    buffer_store_dword v22, v8, s[24:27], s33 offen offset:512 sc1
    s_mov_b64 exec, -1
    s_add_u32 m0, s31, 32768
    s_add_u32 s54, s6, 2
    s_and_b32 s54, s54, 3
    s_lshl_b32 s54, s54, 2
    s_add_u32 s54, s54, 0
    s_add_u32 s54, s54, s63
    s_mul_i32 s54, s54, 36864
    s_add_u32 s54, s54, s35
    buffer_load_dwordx4 v5, s[16:19], s54 offen lds
    s_add_u32 m0, s31, 33792
    s_add_u32 s54, s54, 9216
    buffer_load_dwordx4 v5, s[16:19], s54 offen lds
    s_add_u32 m0, s31, 34816
    s_add_u32 s54, s54, 9216
    buffer_load_dwordx4 v5, s[16:19], s54 offen lds
    s_add_u32 m0, s31, 35840
    s_add_u32 s54, s54, 9216
    buffer_load_dwordx4 v5, s[16:19], s54 offen lds
    s_waitcnt vmcnt(9)
    s_barrier
    s_add_u32 m0, s31, 98304
    s_add_u32 s54, s6, 3
    s_and_b32 s54, s54, 3
    s_lshl_b32 s54, s54, 2
    s_add_u32 s54, s54, 0
    s_add_u32 s54, s54, s63
    s_mul_i32 s54, s54, 36864
    s_add_u32 s54, s54, s35
    buffer_load_dwordx4 v5, s[16:19], s54 offen lds
    s_add_u32 m0, s31, 99328
    s_add_u32 s54, s54, 9216
    buffer_load_dwordx4 v5, s[16:19], s54 offen lds
    s_add_u32 m0, s31, 100352
    s_add_u32 s54, s54, 9216
    buffer_load_dwordx4 v5, s[16:19], s54 offen lds
    s_add_u32 m0, s31, 101376
    s_add_u32 s54, s54, 9216
    buffer_load_dwordx4 v5, s[16:19], s54 offen lds
    s_waitcnt vmcnt(9)
    s_barrier
    v_mov_b32 v22, s64
    s_mov_b64 exec, 0xffffffff
    buffer_store_dword v22, v8, s[24:27], s33 offen offset:1024 sc1
    s_mov_b64 exec, -1
    s_add_u32 m0, s31, 49152
    s_lshr_b32 s54, s62, 1
    s_add_u32 s54, s54, 1
    s_add_u32 s54, s54, s6
    s_and_b32 s54, s54, 3
    s_lshl_b32 s54, s54, 2
    s_add_u32 s54, s54, 2
    s_add_u32 s54, s54, s63
    s_mul_i32 s54, s54, 36864
    s_add_u32 s54, s54, s52
    buffer_load_dwordx4 v5, s[16:19], s54 offen lds
    s_add_u32 m0, s31, 50176
    s_add_u32 s54, s54, 9216
    buffer_load_dwordx4 v5, s[16:19], s54 offen lds
    s_add_u32 m0, s31, 51200
    s_add_u32 s54, s54, 9216
    buffer_load_dwordx4 v5, s[16:19], s54 offen lds
    s_add_u32 m0, s31, 52224
    s_add_u32 s54, s54, 9216
    buffer_load_dwordx4 v5, s[16:19], s54 offen lds
    s_add_u32 s55, s32, 512
    s_mov_b64 exec, 0xf
    buffer_load_dword v23, v7, s[24:27], s55 offen sc1
    s_mov_b64 exec, -1
    s_barrier
    s_add_u32 m0, s31, 81920
    s_lshr_b32 s54, s62, 1
    s_add_u32 s54, s54, 3
    s_add_u32 s54, s54, s6
    s_and_b32 s54, s54, 3
    s_lshl_b32 s54, s54, 2
    s_add_u32 s54, s54, 2
    s_add_u32 s54, s54, s63
    s_mul_i32 s54, s54, 36864
    s_lshl_b32 s55, s63, 1
    s_add_u32 s55, s55, s6
    s_add_u32 s55, s55, 0
    s_and_b32 s55, s55, 3
    s_mul_i32 s55, s55, 18432
    s_add_u32 s55, s55, 589824
    s_cmp_ge_u32 s62, 2
    s_cselect_b32 s54, s55, s54
    s_add_u32 s54, s54, s52
    buffer_load_dwordx4 v5, s[16:19], s54 offen lds
    s_add_u32 m0, s31, 82944
    s_add_u32 s54, s54, 9216
    buffer_load_dwordx4 v5, s[16:19], s54 offen lds
    s_add_u32 m0, s31, 83968
    s_lshr_b32 s54, s62, 1
    s_add_u32 s54, s54, 3
    s_add_u32 s54, s54, s6
    s_and_b32 s54, s54, 3
    s_lshl_b32 s54, s54, 2
    s_add_u32 s54, s54, 2
    s_add_u32 s54, s54, s63
    s_mul_i32 s54, s54, 36864
    s_add_u32 s54, s54, 18432
    s_lshl_b32 s55, s63, 1
    s_add_u32 s55, s55, s6
    s_add_u32 s55, s55, 1
    s_and_b32 s55, s55, 3
    s_mul_i32 s55, s55, 18432
    s_add_u32 s55, s55, 589824
    s_cmp_ge_u32 s62, 2
    s_cselect_b32 s54, s55, s54
    s_add_u32 s54, s54, s52
    buffer_load_dwordx4 v5, s[16:19], s54 offen lds
    s_add_u32 m0, s31, 84992
    s_add_u32 s54, s54, 9216
    buffer_load_dwordx4 v5, s[16:19], s54 offen lds
    s_waitcnt vmcnt(4)
    s_mov_b64 exec, 0xf
    v_cmp_ne_u32 vcc, s64, v23
    s_cbranch_vccnz L_pslow1
L_pcont1:
    s_mov_b64 exec, -1
    s_add_u32 m0, s31, 65536
    s_add_u32 s55, s6, 1
    s_and_b32 s55, s55, 3
    s_lshl_b32 s55, s55, 3
    s_and_b32 s54, s2, 0xe7
    s_or_b32 s55, s55, s54
    s_lshl_b32 s54, s55, 15
    s_add_u32 s54, s54, s30
    s_add_u32 s54, s54, 4210688
    buffer_load_dwordx4 v6, s[24:27], s54 offen sc1 lds
    s_add_u32 m0, s31, 66560
    s_add_u32 s54, s54, 4096
    buffer_load_dwordx4 v6, s[24:27], s54 offen sc1 lds
    s_add_u32 m0, s31, 67584
    s_add_u32 s54, s54, 4096
    buffer_load_dwordx4 v6, s[24:27], s54 offen sc1 lds
    s_add_u32 m0, s31, 68608
    s_add_u32 s54, s54, 4096
    buffer_load_dwordx4 v6, s[24:27], s54 offen sc1 lds
    s_barrier
    s_add_u32 m0, s31, 114688
    s_add_u32 s55, s6, 2
    s_and_b32 s55, s55, 3
    s_lshl_b32 s55, s55, 3
    s_and_b32 s54, s2, 0xe7
    s_or_b32 s55, s55, s54
    s_lshl_b32 s54, s55, 15
    s_add_u32 s54, s54, s30
    s_add_u32 s54, s54, 4210688
    buffer_load_dwordx4 v6, s[24:27], s54 offen sc1 lds
    s_add_u32 m0, s31, 115712
    s_add_u32 s54, s54, 4096
    buffer_load_dwordx4 v6, s[24:27], s54 offen sc1 lds
    s_add_u32 m0, s31, 116736
    s_add_u32 s54, s54, 4096
    buffer_load_dwordx4 v6, s[24:27], s54 offen sc1 lds
    s_add_u32 m0, s31, 117760
    s_add_u32 s54, s54, 4096
    buffer_load_dwordx4 v6, s[24:27], s54 offen sc1 lds
    s_add_u32 m0, s31, 0
    s_add_u32 s55, s6, 3
    s_and_b32 s55, s55, 3
    s_lshl_b32 s55, s55, 3
    s_and_b32 s54, s2, 0xe7
    s_or_b32 s55, s55, s54
    s_lshl_b32 s54, s55, 15
    s_add_u32 s54, s54, s30
    s_add_u32 s54, s54, 4210688
    buffer_load_dwordx4 v6, s[24:27], s54 offen sc1 lds
    s_add_u32 m0, s31, 1024
    s_add_u32 s54, s54, 4096
    buffer_load_dwordx4 v6, s[24:27], s54 offen sc1 lds
    s_add_u32 m0, s31, 2048
    s_add_u32 s54, s54, 4096
    buffer_load_dwordx4 v6, s[24:27], s54 offen sc1 lds
    s_add_u32 m0, s31, 3072
    s_add_u32 s54, s54, 4096
    buffer_load_dwordx4 v6, s[24:27], s54 offen sc1 lds
    s_add_u32 s55, s32, 1024
    s_mov_b64 exec, 0xf
    buffer_load_dword v23, v7, s[24:27], s55 offen sc1
    s_mov_b64 exec, -1
    s_barrier
    s_waitcnt vmcnt(0)
    s_mov_b64 exec, 0xf
    v_cmp_ne_u32 vcc, s64, v23
    s_cbranch_vccnz L_pslow2
L_pcont2:
    s_mov_b64 exec, -1
    s_add_u32 m0, s31, 131072
    s_add_u32 s55, s6, 1
    s_and_b32 s55, s55, 3
    s_lshl_b32 s55, s55, 3
    s_and_b32 s54, s2, 0xe7
    s_or_b32 s55, s55, s54
    s_lshl_b32 s54, s55, 12
    s_add_u32 s54, s54, s30
    s_add_u32 s54, s54, 12582912
    buffer_load_dwordx4 v6, s[24:27], s54 offen sc1 lds
    s_add_u32 m0, s31, 132096
    s_add_u32 s55, s6, 2
    s_and_b32 s55, s55, 3
    s_lshl_b32 s55, s55, 3
    s_and_b32 s54, s2, 0xe7
    s_or_b32 s55, s55, s54
    s_lshl_b32 s54, s55, 12
    s_add_u32 s54, s54, s30
    s_add_u32 s54, s54, 12582912
    buffer_load_dwordx4 v6, s[24:27], s54 offen sc1 lds
    s_add_u32 m0, s31, 133120
    s_add_u32 s55, s6, 3
    s_and_b32 s55, s55, 3
    s_lshl_b32 s55, s55, 3
    s_and_b32 s54, s2, 0xe7
    s_or_b32 s55, s55, s54
    s_lshl_b32 s54, s55, 12
    s_add_u32 s54, s54, s30
    s_add_u32 s54, s54, 12582912
    buffer_load_dwordx4 v6, s[24:27], s54 offen sc1 lds
    s_add_u32 m0, s31, 134144
    s_lshl_b32 s54, s63, 1
    s_add_u32 s54, s54, s6
    v_lshrrev_b32 v19, 5, v0
    v_add_u32 v19, s54, v19
    v_and_b32 v19, 3, v19
    s_branch L_skiplpad2
.p2align 12
L_lpad2:
    s_setpc_b64 s[50:51]
L_skiplpad2:
    v_lshlrev_b32 v19, 9, v19
    v_and_b32 v20, 31, v0
    v_lshl_add_u32 v19, v20, 4, v19
    s_add_u32 s54, s59, 16384
    buffer_load_dwordx4 v19, s[24:27], s54 offen sc1 lds
    s_barrier
    s_add_u32 m0, s31, 147456
    s_lshr_b32 s54, s62, 1
    s_add_u32 s54, s54, 1
    s_add_u32 s54, s54, s6
    s_and_b32 s54, s54, 3
    s_lshl_b32 s54, s54, 2
    s_add_u32 s54, s54, 2
    s_add_u32 s54, s54, s63
    s_mul_i32 s54, s54, 36864
    s_add_u32 s54, s54, s52
    s_add_u32 s54, s54, 128
    buffer_load_dwordx4 v5, s[16:19], s54 offen lds
    s_add_u32 m0, s31, 148480
    s_add_u32 s54, s54, 9216
    buffer_load_dwordx4 v5, s[16:19], s54 offen lds
    s_add_u32 m0, s31, 149504
    s_add_u32 s54, s54, 9216
    buffer_load_dwordx4 v5, s[16:19], s54 offen lds
    s_add_u32 m0, s31, 150528
    s_add_u32 s54, s54, 9216
    buffer_load_dwordx4 v5, s[16:19], s54 offen lds
    s_waitcnt vmcnt(4)
    s_barrier
    s_add_u32 m0, s31, 32768
    s_lshr_b32 s54, s62, 1
    s_add_u32 s54, s54, 3
    s_add_u32 s54, s54, s6
    s_and_b32 s54, s54, 3
    s_lshl_b32 s54, s54, 2
    s_add_u32 s54, s54, 2
    s_add_u32 s54, s54, s63
    s_mul_i32 s54, s54, 36864
    s_lshl_b32 s55, s63, 1
    s_add_u32 s55, s55, s6
    s_add_u32 s55, s55, 0
    s_and_b32 s55, s55, 3
    s_mul_i32 s55, s55, 18432
    s_add_u32 s55, s55, 589824
    s_cmp_ge_u32 s62, 2
    s_cselect_b32 s54, s55, s54
    s_add_u32 s54, s54, s52
    s_add_u32 s54, s54, 128
    buffer_load_dwordx4 v5, s[16:19], s54 offen lds
    s_add_u32 m0, s31, 33792
    s_add_u32 s54, s54, 9216
    buffer_load_dwordx4 v5, s[16:19], s54 offen lds
    s_add_u32 m0, s31, 34816
    s_lshr_b32 s54, s62, 1
    s_add_u32 s54, s54, 3
    s_add_u32 s54, s54, s6
    s_and_b32 s54, s54, 3
    s_lshl_b32 s54, s54, 2
    s_add_u32 s54, s54, 2
    s_add_u32 s54, s54, s63
    s_mul_i32 s54, s54, 36864
    s_add_u32 s54, s54, 18432
    s_lshl_b32 s55, s63, 1
    s_add_u32 s55, s55, s6
    s_add_u32 s55, s55, 1
    s_and_b32 s55, s55, 3
    s_mul_i32 s55, s55, 18432
    s_add_u32 s55, s55, 589824
    s_cmp_ge_u32 s62, 2
    s_cselect_b32 s54, s55, s54
    s_add_u32 s54, s54, s52
    s_add_u32 s54, s54, 128
    buffer_load_dwordx4 v5, s[16:19], s54 offen lds
    s_add_u32 m0, s31, 35840
    s_add_u32 s54, s54, 9216
    buffer_load_dwordx4 v5, s[16:19], s54 offen lds
    s_barrier
    s_waitcnt vmcnt(0)
    s_barrier
    s_setprio 0
    s_lshl_b32 s55, s2, 12
    s_lshl_b32 s54, s62, 7
    s_add_u32 s55, s55, s54
    s_add_u32 s55, s55, 6144
    v_and_b32 v4, 15, v0
    v_mul_u32_u24 v4, 1152, v4
    v_lshrrev_b32 v19, 4, v0
    v_lshl_add_u32 v4, v19, 3, v4
    s_lshl_b32 s54, s5, 7
    s_lshl_b32 s60, s4, 4
    s_add_u32 s54, s54, s60
    s_mul_i32 s60, s54, 1152
    s_lshl_b32 s54, s6, 5
    s_add_u32 s61, s60, s54
    s_add_u32 s61, s61, 1024
    s_lshl_b32 s54, s6, 8
    s_add_u32 s60, s60, s54
    s_lshl_b32 s54, s62, 6
    s_add_u32 s60, s60, s54
    s_lshl_b32 s53, s2, 12
    s_add_u32 s53, s53, 23068672
    s_lshl_b32 s54, s2, 13
    s_lshl_b32 s52, s62, 21
    s_add_u32 s54, s54, s52
    s_add_u32 s54, s54, 14680064
    s_add_u32 s52, s54, 4096
    v_lshlrev_b32 v3, 3, v0
    s_mov_b64 exec, 0xff
    s_mov_b32 s57, 0
L_fin:
    v_mov_b32 v23, 0
    buffer_atomic_add v23, v8, s[24:27], s55 offen sc0 sc1
    s_add_u32 s57, s57, 1
    s_waitcnt vmcnt(0)
    v_cmp_ne_u32 vcc, s64, v23
    s_cbranch_vccz L_find
    s_cmp_lt_u32 s57, 40000
    s_cbranch_scc1 L_fin
L_find:
    s_mov_b64 exec, -1
    buffer_load_dwordx4 v[32:35], v6, s[24:27], s54 offen offset:0 sc1
    buffer_load_dwordx4 v[36:39], v6, s[24:27], s54 offen offset:1024 sc1
    buffer_load_dwordx4 v[40:43], v6, s[24:27], s54 offen offset:2048 sc1
    buffer_load_dwordx4 v[44:47], v6, s[24:27], s54 offen offset:3072 sc1
    buffer_load_dwordx4 v[48:51], v6, s[24:27], s52 offen offset:0 sc1
    buffer_load_dwordx4 v[52:55], v6, s[24:27], s52 offen offset:1024 sc1
    buffer_load_dwordx4 v[56:59], v6, s[24:27], s52 offen offset:2048 sc1
    buffer_load_dwordx4 v[60:63], v6, s[24:27], s52 offen offset:3072 sc1
    s_cmp_lg_u32 s62, 0
    s_cbranch_scc1 L_no8a
    buffer_load_dwordx2 v[64:65], v3, s[24:27], s53 offen offset:0 sc1
    buffer_load_dwordx2 v[66:67], v3, s[24:27], s53 offen offset:512 sc1
    buffer_load_dwordx2 v[68:69], v3, s[24:27], s53 offen offset:1024 sc1
    buffer_load_dwordx2 v[70:71], v3, s[24:27], s53 offen offset:1536 sc1
    buffer_load_dwordx2 v[72:73], v3, s[24:27], s53 offen offset:2048 sc1
    buffer_load_dwordx2 v[74:75], v3, s[24:27], s53 offen offset:2560 sc1
    buffer_load_dwordx2 v[76:77], v3, s[24:27], s53 offen offset:3072 sc1
    buffer_load_dwordx2 v[78:79], v3, s[24:27], s53 offen offset:3584 sc1
L_no8a:
    s_waitcnt vmcnt(7)
    v_lshlrev_b32 v96, 16, v32
    v_and_b32 v97, 0xffff0000, v32
    v_lshlrev_b32 v98, 16, v33
    v_and_b32 v99, 0xffff0000, v33
    v_lshlrev_b32 v100, 16, v34
    v_and_b32 v101, 0xffff0000, v34
    v_lshlrev_b32 v102, 16, v35
    v_and_b32 v103, 0xffff0000, v35
    s_waitcnt vmcnt(6)
    v_lshlrev_b32 v104, 16, v36
    v_and_b32 v105, 0xffff0000, v36
    v_lshlrev_b32 v106, 16, v37
    v_and_b32 v107, 0xffff0000, v37
    v_lshlrev_b32 v108, 16, v38
    v_and_b32 v109, 0xffff0000, v38
    v_lshlrev_b32 v110, 16, v39
    v_and_b32 v111, 0xffff0000, v39
    v_pk_add_f32 v[96:97], v[96:97], v[104:105]
    v_pk_add_f32 v[98:99], v[98:99], v[106:107]
    v_pk_add_f32 v[100:101], v[100:101], v[108:109]
    v_pk_add_f32 v[102:103], v[102:103], v[110:111]
    s_waitcnt vmcnt(5)
    v_lshlrev_b32 v104, 16, v40
    v_and_b32 v105, 0xffff0000, v40
    v_lshlrev_b32 v106, 16, v41
    v_and_b32 v107, 0xffff0000, v41
    v_lshlrev_b32 v108, 16, v42
    v_and_b32 v109, 0xffff0000, v42
    v_lshlrev_b32 v110, 16, v43
    v_and_b32 v111, 0xffff0000, v43
    v_pk_add_f32 v[96:97], v[96:97], v[104:105]
    v_pk_add_f32 v[98:99], v[98:99], v[106:107]
    v_pk_add_f32 v[100:101], v[100:101], v[108:109]
    v_pk_add_f32 v[102:103], v[102:103], v[110:111]
    s_waitcnt vmcnt(4)
    v_lshlrev_b32 v104, 16, v44
    v_and_b32 v105, 0xffff0000, v44
    v_lshlrev_b32 v106, 16, v45
    v_and_b32 v107, 0xffff0000, v45
    v_lshlrev_b32 v108, 16, v46
    v_and_b32 v109, 0xffff0000, v46
    v_lshlrev_b32 v110, 16, v47
    v_and_b32 v111, 0xffff0000, v47
    v_pk_add_f32 v[96:97], v[96:97], v[104:105]
    v_pk_add_f32 v[98:99], v[98:99], v[106:107]
    v_pk_add_f32 v[100:101], v[100:101], v[108:109]
    v_pk_add_f32 v[102:103], v[102:103], v[110:111]
    s_waitcnt vmcnt(3)
    v_lshlrev_b32 v104, 16, v48
    v_and_b32 v105, 0xffff0000, v48
    v_lshlrev_b32 v106, 16, v49
    v_and_b32 v107, 0xffff0000, v49
    v_lshlrev_b32 v108, 16, v50
    v_and_b32 v109, 0xffff0000, v50
    v_lshlrev_b32 v110, 16, v51
    v_and_b32 v111, 0xffff0000, v51
    v_pk_add_f32 v[96:97], v[96:97], v[104:105]
    v_pk_add_f32 v[98:99], v[98:99], v[106:107]
    v_pk_add_f32 v[100:101], v[100:101], v[108:109]
    v_pk_add_f32 v[102:103], v[102:103], v[110:111]
    s_waitcnt vmcnt(2)
    v_lshlrev_b32 v104, 16, v52
    v_and_b32 v105, 0xffff0000, v52
    v_lshlrev_b32 v106, 16, v53
    v_and_b32 v107, 0xffff0000, v53
    v_lshlrev_b32 v108, 16, v54
    v_and_b32 v109, 0xffff0000, v54
    v_lshlrev_b32 v110, 16, v55
    v_and_b32 v111, 0xffff0000, v55
    v_pk_add_f32 v[96:97], v[96:97], v[104:105]
    v_pk_add_f32 v[98:99], v[98:99], v[106:107]
    v_pk_add_f32 v[100:101], v[100:101], v[108:109]
    v_pk_add_f32 v[102:103], v[102:103], v[110:111]
    s_waitcnt vmcnt(1)
    v_lshlrev_b32 v104, 16, v56
    v_and_b32 v105, 0xffff0000, v56
    v_lshlrev_b32 v106, 16, v57
    v_and_b32 v107, 0xffff0000, v57
    v_lshlrev_b32 v108, 16, v58
    v_and_b32 v109, 0xffff0000, v58
    v_lshlrev_b32 v110, 16, v59
    v_and_b32 v111, 0xffff0000, v59
    v_pk_add_f32 v[96:97], v[96:97], v[104:105]
    v_pk_add_f32 v[98:99], v[98:99], v[106:107]
    v_pk_add_f32 v[100:101], v[100:101], v[108:109]
    v_pk_add_f32 v[102:103], v[102:103], v[110:111]
    s_waitcnt vmcnt(0)
    v_lshlrev_b32 v104, 16, v60
    v_and_b32 v105, 0xffff0000, v60
    v_lshlrev_b32 v106, 16, v61
    v_and_b32 v107, 0xffff0000, v61
    v_lshlrev_b32 v108, 16, v62
    v_and_b32 v109, 0xffff0000, v62
    v_lshlrev_b32 v110, 16, v63
    v_and_b32 v111, 0xffff0000, v63
    v_pk_add_f32 v[96:97], v[96:97], v[104:105]
    v_pk_add_f32 v[98:99], v[98:99], v[106:107]
    v_pk_add_f32 v[100:101], v[100:101], v[108:109]
    v_pk_add_f32 v[102:103], v[102:103], v[110:111]
    v_cvt_pk_bf16_f32 v96, v96, v97
    v_cvt_pk_bf16_f32 v97, v98, v99
    v_cvt_pk_bf16_f32 v98, v100, v101
    v_cvt_pk_bf16_f32 v99, v102, v103
    buffer_store_dwordx2 v[96:97], v4, s[20:23], s60 offen
    buffer_store_dwordx2 v[98:99], v4, s[20:23], s60 offen offset:32
    s_cmp_lg_u32 s62, 0
    s_cbranch_scc1 L_no8b
    v_lshlrev_b32 v80, 16, v64
    v_and_b32 v81, 0xffff0000, v64
    v_lshlrev_b32 v82, 16, v65
    v_and_b32 v83, 0xffff0000, v65
    v_lshlrev_b32 v84, 16, v66
    v_and_b32 v85, 0xffff0000, v66
    v_lshlrev_b32 v86, 16, v67
    v_and_b32 v87, 0xffff0000, v67
    v_pk_add_f32 v[80:81], v[80:81], v[84:85]
    v_pk_add_f32 v[82:83], v[82:83], v[86:87]
    v_lshlrev_b32 v84, 16, v68
    v_and_b32 v85, 0xffff0000, v68
    v_lshlrev_b32 v86, 16, v69
    v_and_b32 v87, 0xffff0000, v69
    v_pk_add_f32 v[80:81], v[80:81], v[84:85]
    v_pk_add_f32 v[82:83], v[82:83], v[86:87]
    v_lshlrev_b32 v84, 16, v70
    v_and_b32 v85, 0xffff0000, v70
    v_lshlrev_b32 v86, 16, v71
    v_and_b32 v87, 0xffff0000, v71
    v_pk_add_f32 v[80:81], v[80:81], v[84:85]
    v_pk_add_f32 v[82:83], v[82:83], v[86:87]
    v_lshlrev_b32 v84, 16, v72
    v_and_b32 v85, 0xffff0000, v72
    v_lshlrev_b32 v86, 16, v73
    v_and_b32 v87, 0xffff0000, v73
    v_pk_add_f32 v[80:81], v[80:81], v[84:85]
    v_pk_add_f32 v[82:83], v[82:83], v[86:87]
    v_lshlrev_b32 v84, 16, v74
    v_and_b32 v85, 0xffff0000, v74
    v_lshlrev_b32 v86, 16, v75
    v_and_b32 v87, 0xffff0000, v75
    v_pk_add_f32 v[80:81], v[80:81], v[84:85]
    v_pk_add_f32 v[82:83], v[82:83], v[86:87]
    v_lshlrev_b32 v84, 16, v76
    v_and_b32 v85, 0xffff0000, v76
    v_lshlrev_b32 v86, 16, v77
    v_and_b32 v87, 0xffff0000, v77
    v_pk_add_f32 v[80:81], v[80:81], v[84:85]
    v_pk_add_f32 v[82:83], v[82:83], v[86:87]
    v_lshlrev_b32 v84, 16, v78
    v_and_b32 v85, 0xffff0000, v78
    v_lshlrev_b32 v86, 16, v79
    v_and_b32 v87, 0xffff0000, v79
    v_pk_add_f32 v[80:81], v[80:81], v[84:85]
    v_pk_add_f32 v[82:83], v[82:83], v[86:87]
    v_cvt_pk_bf16_f32 v80, v80, v81
    v_cvt_pk_bf16_f32 v81, v82, v83
    buffer_store_dwordx2 v[80:81], v4, s[20:23], s61 offen
    s_cmp_lg_u32 s2, 0
    s_cbranch_scc1 L_no8b
    s_mov_b64 exec, 1
    v_mov_b32 v22, s64
    s_mov_b32 s55, 0
    buffer_store_dword v22, off, s[24:27], s55 sc1
    s_mov_b64 exec, -1
L_no8b:
L_end:
    s_endpgm
L_pslow3:
    s_mov_b32 s55, s44
    s_call_b64 s[50:51], L_poll
    s_branch L_pcont3
L_pslow0:
    s_add_u32 s55, s32, 0
    s_call_b64 s[50:51], L_poll
    s_branch L_pcont0
L_pslow1:
    s_add_u32 s55, s32, 512
    s_call_b64 s[50:51], L_poll
    s_branch L_pcont1
L_pslow2:
    s_add_u32 s55, s32, 1024
    s_call_b64 s[50:51], L_poll
    s_branch L_pcont2
L_poll:
    s_mov_b32 s57, 0
L_poll_l:
    buffer_load_dword v23, v7, s[24:27], s55 offen sc1
    s_waitcnt vmcnt(0)
    v_cmp_ne_u32 vcc, s64, v23
    s_cbranch_vccz L_poll_r
    s_add_u32 s57, s57, 1
    s_cmp_lt_u32 s57, 40000
    s_cbranch_scc1 L_poll_l
L_poll_r:
    s_setpc_b64 s[50:51]
.p2align 12
L_mfma:
    v_lshrrev_b32 v8, 4, v0
    v_bfe_u32 v9, v0, 2, 2
    v_and_b32 v10, 3, v0
    v_lshlrev_b32 v10, 3, v10
    v_lshl_add_u32 v11, v8, 3, v9
    v_lshl_add_u32 v2, v11, 7, v10
    v_lshrrev_b32 v11, 1, v9
    v_and_b32 v12, 1, v8
    v_lshl_add_u32 v11, v12, 1, v11
    v_lshl_add_u32 v2, v11, 5, v2
    v_xor_b32 v3, 32, v2
    v_xor_b32 v4, 64, v2
    v_xor_b32 v5, 96, v2
    v_and_b32 v11, 15, v0
    v_lshrrev_b32 v12, 1, v11
    v_xor_b32 v12, v12, v8
    v_lshlrev_b32 v12, 4, v12
    v_lshl_add_u32 v6, v11, 7, v12
    s_lshl_b32 s31, s3, 12
    s_add_u32 s54, s31, 65536
    v_add_u32 v6, s54, v6
    v_xor_b32 v1, 64, v6
    v_mov_b32 v7, 0xc0135761
    s_mov_b32 s56, 0xbdd2d3e8
    s_mov_b32 s57, 0xbdd2d3e8
    s_lshl_b32 s54, s2, 5
    s_add_u32 s54, s54, s3
    s_lshl_b32 s8, s54, 10
    s_add_u32 s8, s8, 4194304
    s_add_u32 s9, s8, 4096
    s_add_u32 s10, s8, 8192
    s_add_u32 s11, s8, 12288
    s_add_u32 s12, s8, 16384
    s_add_u32 s13, s8, 20480
    s_add_u32 s14, s8, 24576
    s_add_u32 s15, s8, 28672
    s_lshl_b32 s54, s2, 2
    s_add_u32 s54, s54, s3
    s_lshl_b32 s16, s54, 10
    s_add_u32 s16, s16, 12582912
    s_and_b32 s54, s2, 0xf8
    s_lshl_b32 s55, s3, 1
    s_add_u32 s54, s54, s55
    s_lshl_b32 s21, s54, 10
    s_add_u32 s21, s21, s4
    s_lshl_b32 s21, s21, 2
    s_add_u32 s21, s21, 6144
    s_mov_b32 s55, s4
    s_and_b32 s55, s55, 7
    s_lshl_b32 s53, s54, 3
    s_add_u32 s55, s55, s53
    s_lshl_b32 s19, s55, 9
    s_add_u32 s19, s19, 23068672
    s_lshl_b32 s17, s55, 10
    s_add_u32 s17, s17, 14680064
    s_add_u32 s54, s54, 1
    s_mov_b32 s55, s4
    s_and_b32 s55, s55, 7
    s_lshl_b32 s53, s54, 3
    s_add_u32 s55, s55, s53
    s_lshl_b32 s20, s55, 9
    s_add_u32 s20, s20, 23068672
    s_lshl_b32 s18, s55, 10
    s_add_u32 s18, s18, 14680064
    s_add_u32 s54, s54, 1
    s_lshl_b32 s22, s2, 12
    s_lshl_b32 s54, s3, 7
    s_add_u32 s22, s22, s54
    s_add_u32 s22, s22, 4096
    s_waitcnt lgkmcnt(0)
    s_load_dword s64, s[48:49], 0
    s_mov_b32 s24, s48
    s_mov_b32 s25, s49
    s_mov_b32 s26, 33554432
    s_mov_b32 s27, 0x00020000
    s_waitcnt vmcnt(0)
    s_cmp_lg_u32 s3, 1
    s_cbranch_scc1 L_nl1
    s_call_b64 s[50:51], L_lpad1
L_nl1:
    s_cmp_lg_u32 s3, 2
    s_cbranch_scc1 L_nl2
    s_call_b64 s[50:51], L_lpad2
L_nl2:
    s_barrier
    ds_read_b128 a[0:3], v6 offset:0
    ds_read_b128 a[4:7], v6 offset:2048
    ds_read_b64_tr_b16 v[16:17], v2 offset:0
    ds_read_b64_tr_b16 v[18:19], v2 offset:512
    ds_read_b64_tr_b16 v[20:21], v2 offset:8192
    ds_read_b64_tr_b16 v[22:23], v2 offset:8704
    ds_read_b64_tr_b16 v[24:25], v3 offset:0
    ds_read_b64_tr_b16 v[26:27], v3 offset:512
    ds_read_b64_tr_b16 v[28:29], v3 offset:8192
    s_waitcnt lgkmcnt(3)
    v_mfma_f32_16x16x32_bf16 v[48:51], v[16:19], a[0:3], 0
    ds_read_b64_tr_b16 v[30:31], v3 offset:8704
    ds_read_b128 a[8:11], v1 offset:0
    v_mfma_f32_16x16x32_bf16 v[64:67], v[16:19], a[4:7], 0
    ds_read_b64_tr_b16 v[16:17], v4 offset:0
    v_mfma_f32_16x16x32_bf16 v[56:59], v[20:23], a[0:3], 0
    ds_read_b64_tr_b16 v[18:19], v4 offset:512
    ds_read_b128 a[12:15], v1 offset:2048
    v_mfma_f32_16x16x32_bf16 v[72:75], v[20:23], a[4:7], 0
    ds_read_b64_tr_b16 v[20:21], v4 offset:8192
    s_waitcnt lgkmcnt(5)
    v_mfma_f32_16x16x32_bf16 v[52:55], v[24:27], a[0:3], 0
    ds_read_b64_tr_b16 v[22:23], v4 offset:8704
    v_mfma_f32_16x16x32_bf16 v[68:71], v[24:27], a[4:7], 0
    ds_read_b64_tr_b16 v[24:25], v5 offset:0
    v_mfma_f32_16x16x32_bf16 v[60:63], v[28:31], a[0:3], 0
    ds_read_b64_tr_b16 v[26:27], v5 offset:512
    v_mfma_f32_16x16x32_bf16 v[76:79], v[28:31], a[4:7], 0
    ds_read_b64_tr_b16 v[28:29], v5 offset:8192
    s_waitcnt lgkmcnt(3)
    v_mfma_f32_16x16x32_bf16 v[80:83], v[16:19], a[0:3], 0
    ds_read_b64_tr_b16 v[30:31], v5 offset:8704
    v_mfma_f32_16x16x32_bf16 v[96:99], v[16:19], a[4:7], 0
    ds_read_b64_tr_b16 v[16:17], v2 offset:4096
    v_mfma_f32_16x16x32_bf16 v[88:91], v[20:23], a[0:3], 0
    ds_read_b64_tr_b16 v[18:19], v2 offset:4608
    v_mfma_f32_16x16x32_bf16 v[104:107], v[20:23], a[4:7], 0
    ds_read_b64_tr_b16 v[20:21], v2 offset:12288
    s_waitcnt lgkmcnt(3)
    v_mfma_f32_16x16x32_bf16 v[84:87], v[24:27], a[0:3], 0
    ds_read_b64_tr_b16 v[22:23], v2 offset:12800
    v_mfma_f32_16x16x32_bf16 v[100:103], v[24:27], a[4:7], 0
    ds_read_b64_tr_b16 v[24:25], v3 offset:4096
    v_mfma_f32_16x16x32_bf16 v[92:95], v[28:31], a[0:3], 0
    ds_read_b64_tr_b16 v[26:27], v3 offset:4608
    v_mfma_f32_16x16x32_bf16 v[108:111], v[28:31], a[4:7], 0
    ds_read_b64_tr_b16 v[28:29], v3 offset:12288
    s_waitcnt lgkmcnt(3)
    v_mfma_f32_16x16x32_bf16 v[48:51], v[16:19], a[8:11], v[48:51]
    ds_read_b64_tr_b16 v[30:31], v3 offset:12800
    v_mfma_f32_16x16x32_bf16 v[64:67], v[16:19], a[12:15], v[64:67]
    ds_read_b64_tr_b16 v[16:17], v4 offset:4096
    v_mfma_f32_16x16x32_bf16 v[56:59], v[20:23], a[8:11], v[56:59]
    ds_read_b64_tr_b16 v[18:19], v4 offset:4608
    v_mfma_f32_16x16x32_bf16 v[72:75], v[20:23], a[12:15], v[72:75]
    ds_read_b64_tr_b16 v[20:21], v4 offset:12288
    s_waitcnt lgkmcnt(3)
    v_mfma_f32_16x16x32_bf16 v[52:55], v[24:27], a[8:11], v[52:55]
    ds_read_b64_tr_b16 v[22:23], v4 offset:12800
    v_mfma_f32_16x16x32_bf16 v[68:71], v[24:27], a[12:15], v[68:71]
    ds_read_b64_tr_b16 v[24:25], v5 offset:4096
    v_mfma_f32_16x16x32_bf16 v[60:63], v[28:31], a[8:11], v[60:63]
    ds_read_b64_tr_b16 v[26:27], v5 offset:4608
    v_mfma_f32_16x16x32_bf16 v[76:79], v[28:31], a[12:15], v[76:79]
    ds_read_b64_tr_b16 v[28:29], v5 offset:12288
    s_waitcnt lgkmcnt(3)
    v_mfma_f32_16x16x32_bf16 v[80:83], v[16:19], a[8:11], v[80:83]
    ds_read_b64_tr_b16 v[30:31], v5 offset:12800
    v_mfma_f32_16x16x32_bf16 v[96:99], v[16:19], a[12:15], v[96:99]
    s_barrier
    ds_read_b128 a[16:19], v6 offset:16384
    ds_read_b128 a[20:23], v6 offset:18432
    ds_read_b64_tr_b16 v[16:17], v2 offset:16384
    v_mfma_f32_16x16x32_bf16 v[88:91], v[20:23], a[8:11], v[88:91]
    ds_read_b64_tr_b16 v[18:19], v2 offset:16896
    v_mfma_f32_16x16x32_bf16 v[104:107], v[20:23], a[12:15], v[104:107]
    ds_read_b64_tr_b16 v[20:21], v2 offset:24576
    s_waitcnt lgkmcnt(5)
    v_mfma_f32_16x16x32_bf16 v[84:87], v[24:27], a[8:11], v[84:87]
    ds_read_b64_tr_b16 v[22:23], v2 offset:25088
    v_mfma_f32_16x16x32_bf16 v[100:103], v[24:27], a[12:15], v[100:103]
    ds_read_b64_tr_b16 v[24:25], v3 offset:16384
    v_mfma_f32_16x16x32_bf16 v[92:95], v[28:31], a[8:11], v[92:95]
    ds_read_b64_tr_b16 v[26:27], v3 offset:16896
    v_mfma_f32_16x16x32_bf16 v[108:111], v[28:31], a[12:15], v[108:111]
    ds_read_b64_tr_b16 v[28:29], v3 offset:24576
    s_waitcnt lgkmcnt(3)
    v_mfma_f32_16x16x32_bf16 v[48:51], v[16:19], a[16:19], v[48:51]
    ds_read_b64_tr_b16 v[30:31], v3 offset:25088
    ds_read_b128 a[24:27], v1 offset:16384
    v_mfma_f32_16x16x32_bf16 v[64:67], v[16:19], a[20:23], v[64:67]
    ds_read_b64_tr_b16 v[16:17], v4 offset:16384
    v_mfma_f32_16x16x32_bf16 v[56:59], v[20:23], a[16:19], v[56:59]
    ds_read_b64_tr_b16 v[18:19], v4 offset:16896
    ds_read_b128 a[28:31], v1 offset:18432
    v_mfma_f32_16x16x32_bf16 v[72:75], v[20:23], a[20:23], v[72:75]
    ds_read_b64_tr_b16 v[20:21], v4 offset:24576
    s_waitcnt lgkmcnt(5)
    v_mfma_f32_16x16x32_bf16 v[52:55], v[24:27], a[16:19], v[52:55]
    ds_read_b64_tr_b16 v[22:23], v4 offset:25088
    v_mfma_f32_16x16x32_bf16 v[68:71], v[24:27], a[20:23], v[68:71]
    ds_read_b64_tr_b16 v[24:25], v5 offset:16384
    v_mfma_f32_16x16x32_bf16 v[60:63], v[28:31], a[16:19], v[60:63]
    ds_read_b64_tr_b16 v[26:27], v5 offset:16896
    v_mfma_f32_16x16x32_bf16 v[76:79], v[28:31], a[20:23], v[76:79]
    ds_read_b64_tr_b16 v[28:29], v5 offset:24576
    s_waitcnt lgkmcnt(3)
    v_mfma_f32_16x16x32_bf16 v[80:83], v[16:19], a[16:19], v[80:83]
    ds_read_b64_tr_b16 v[30:31], v5 offset:25088
    v_mfma_f32_16x16x32_bf16 v[96:99], v[16:19], a[20:23], v[96:99]
    ds_read_b64_tr_b16 v[16:17], v2 offset:20480
    v_mfma_f32_16x16x32_bf16 v[88:91], v[20:23], a[16:19], v[88:91]
    ds_read_b64_tr_b16 v[18:19], v2 offset:20992
    v_mfma_f32_16x16x32_bf16 v[104:107], v[20:23], a[20:23], v[104:107]
    ds_read_b64_tr_b16 v[20:21], v2 offset:28672
    s_waitcnt lgkmcnt(3)
    v_mfma_f32_16x16x32_bf16 v[84:87], v[24:27], a[16:19], v[84:87]
    ds_read_b64_tr_b16 v[22:23], v2 offset:29184
    v_mfma_f32_16x16x32_bf16 v[100:103], v[24:27], a[20:23], v[100:103]
    ds_read_b64_tr_b16 v[24:25], v3 offset:20480
    v_mfma_f32_16x16x32_bf16 v[92:95], v[28:31], a[16:19], v[92:95]
    ds_read_b64_tr_b16 v[26:27], v3 offset:20992
    v_mfma_f32_16x16x32_bf16 v[108:111], v[28:31], a[20:23], v[108:111]
    ds_read_b64_tr_b16 v[28:29], v3 offset:28672
    s_waitcnt lgkmcnt(3)
    v_mfma_f32_16x16x32_bf16 v[48:51], v[16:19], a[24:27], v[48:51]
    ds_read_b64_tr_b16 v[30:31], v3 offset:29184
    v_mfma_f32_16x16x32_bf16 v[64:67], v[16:19], a[28:31], v[64:67]
    ds_read_b64_tr_b16 v[16:17], v4 offset:20480
    v_mfma_f32_16x16x32_bf16 v[56:59], v[20:23], a[24:27], v[56:59]
    ds_read_b64_tr_b16 v[18:19], v4 offset:20992
    v_mfma_f32_16x16x32_bf16 v[72:75], v[20:23], a[28:31], v[72:75]
    ds_read_b64_tr_b16 v[20:21], v4 offset:28672
    s_waitcnt lgkmcnt(3)
    v_mfma_f32_16x16x32_bf16 v[52:55], v[24:27], a[24:27], v[52:55]
    ds_read_b64_tr_b16 v[22:23], v4 offset:29184
    v_mfma_f32_16x16x32_bf16 v[68:71], v[24:27], a[28:31], v[68:71]
    ds_read_b64_tr_b16 v[24:25], v5 offset:20480
    v_mfma_f32_16x16x32_bf16 v[60:63], v[28:31], a[24:27], v[60:63]
    ds_read_b64_tr_b16 v[26:27], v5 offset:20992
    v_mfma_f32_16x16x32_bf16 v[76:79], v[28:31], a[28:31], v[76:79]
    ds_read_b64_tr_b16 v[28:29], v5 offset:28672
    s_waitcnt lgkmcnt(3)
    v_mfma_f32_16x16x32_bf16 v[80:83], v[16:19], a[24:27], v[80:83]
    ds_read_b64_tr_b16 v[30:31], v5 offset:29184
    v_mfma_f32_16x16x32_bf16 v[96:99], v[16:19], a[28:31], v[96:99]
    s_barrier
    ds_read_b128 a[32:35], v6 offset:32768
    ds_read_b128 a[36:39], v6 offset:34816
    ds_read_b64_tr_b16 v[16:17], v2 offset:32768
    v_mfma_f32_16x16x32_bf16 v[88:91], v[20:23], a[24:27], v[88:91]
    ds_read_b64_tr_b16 v[18:19], v2 offset:33280
    v_mfma_f32_16x16x32_bf16 v[104:107], v[20:23], a[28:31], v[104:107]
    ds_read_b64_tr_b16 v[20:21], v2 offset:40960
    s_waitcnt lgkmcnt(5)
    v_mfma_f32_16x16x32_bf16 v[84:87], v[24:27], a[24:27], v[84:87]
    ds_read_b64_tr_b16 v[22:23], v2 offset:41472
    v_mfma_f32_16x16x32_bf16 v[100:103], v[24:27], a[28:31], v[100:103]
    ds_read_b64_tr_b16 v[24:25], v3 offset:32768
    v_mfma_f32_16x16x32_bf16 v[92:95], v[28:31], a[24:27], v[92:95]
    ds_read_b64_tr_b16 v[26:27], v3 offset:33280
    v_mfma_f32_16x16x32_bf16 v[108:111], v[28:31], a[28:31], v[108:111]
    ds_read_b64_tr_b16 v[28:29], v3 offset:40960
    s_waitcnt lgkmcnt(3)
    v_mfma_f32_16x16x32_bf16 v[48:51], v[16:19], a[32:35], v[48:51]
    ds_read_b64_tr_b16 v[30:31], v3 offset:41472
    ds_read_b128 a[40:43], v1 offset:32768
    v_mfma_f32_16x16x32_bf16 v[64:67], v[16:19], a[36:39], v[64:67]
    ds_read_b64_tr_b16 v[16:17], v4 offset:32768
    v_mfma_f32_16x16x32_bf16 v[56:59], v[20:23], a[32:35], v[56:59]
    ds_read_b64_tr_b16 v[18:19], v4 offset:33280
    ds_read_b128 a[44:47], v1 offset:34816
    v_mfma_f32_16x16x32_bf16 v[72:75], v[20:23], a[36:39], v[72:75]
    ds_read_b64_tr_b16 v[20:21], v4 offset:40960
    s_waitcnt lgkmcnt(5)
    v_mfma_f32_16x16x32_bf16 v[52:55], v[24:27], a[32:35], v[52:55]
    ds_read_b64_tr_b16 v[22:23], v4 offset:41472
    v_mfma_f32_16x16x32_bf16 v[68:71], v[24:27], a[36:39], v[68:71]
    ds_read_b64_tr_b16 v[24:25], v5 offset:32768
    v_mfma_f32_16x16x32_bf16 v[60:63], v[28:31], a[32:35], v[60:63]
    ds_read_b64_tr_b16 v[26:27], v5 offset:33280
    v_mfma_f32_16x16x32_bf16 v[76:79], v[28:31], a[36:39], v[76:79]
    ds_read_b64_tr_b16 v[28:29], v5 offset:40960
    s_waitcnt lgkmcnt(3)
    v_mfma_f32_16x16x32_bf16 v[80:83], v[16:19], a[32:35], v[80:83]
    ds_read_b64_tr_b16 v[30:31], v5 offset:41472
    v_mfma_f32_16x16x32_bf16 v[96:99], v[16:19], a[36:39], v[96:99]
    ds_read_b64_tr_b16 v[16:17], v2 offset:36864
    v_mfma_f32_16x16x32_bf16 v[88:91], v[20:23], a[32:35], v[88:91]
    ds_read_b64_tr_b16 v[18:19], v2 offset:37376
    v_mfma_f32_16x16x32_bf16 v[104:107], v[20:23], a[36:39], v[104:107]
    ds_read_b64_tr_b16 v[20:21], v2 offset:45056
    s_waitcnt lgkmcnt(3)
    v_mfma_f32_16x16x32_bf16 v[84:87], v[24:27], a[32:35], v[84:87]
    ds_read_b64_tr_b16 v[22:23], v2 offset:45568
    v_mfma_f32_16x16x32_bf16 v[100:103], v[24:27], a[36:39], v[100:103]
    ds_read_b64_tr_b16 v[24:25], v3 offset:36864
    v_mfma_f32_16x16x32_bf16 v[92:95], v[28:31], a[32:35], v[92:95]
    ds_read_b64_tr_b16 v[26:27], v3 offset:37376
    v_mfma_f32_16x16x32_bf16 v[108:111], v[28:31], a[36:39], v[108:111]
    ds_read_b64_tr_b16 v[28:29], v3 offset:45056
    s_waitcnt lgkmcnt(3)
    v_mfma_f32_16x16x32_bf16 v[48:51], v[16:19], a[40:43], v[48:51]
    ds_read_b64_tr_b16 v[30:31], v3 offset:45568
    v_mfma_f32_16x16x32_bf16 v[64:67], v[16:19], a[44:47], v[64:67]
    ds_read_b64_tr_b16 v[16:17], v4 offset:36864
    v_mfma_f32_16x16x32_bf16 v[56:59], v[20:23], a[40:43], v[56:59]
    ds_read_b64_tr_b16 v[18:19], v4 offset:37376
    v_mfma_f32_16x16x32_bf16 v[72:75], v[20:23], a[44:47], v[72:75]
    ds_read_b64_tr_b16 v[20:21], v4 offset:45056
    s_waitcnt lgkmcnt(3)
    v_mfma_f32_16x16x32_bf16 v[52:55], v[24:27], a[40:43], v[52:55]
    ds_read_b64_tr_b16 v[22:23], v4 offset:45568
    v_mfma_f32_16x16x32_bf16 v[68:71], v[24:27], a[44:47], v[68:71]
    ds_read_b64_tr_b16 v[24:25], v5 offset:36864
    v_mfma_f32_16x16x32_bf16 v[60:63], v[28:31], a[40:43], v[60:63]
    ds_read_b64_tr_b16 v[26:27], v5 offset:37376
    v_mfma_f32_16x16x32_bf16 v[76:79], v[28:31], a[44:47], v[76:79]
    ds_read_b64_tr_b16 v[28:29], v5 offset:45056
    s_waitcnt lgkmcnt(3)
    v_mfma_f32_16x16x32_bf16 v[80:83], v[16:19], a[40:43], v[80:83]
    ds_read_b64_tr_b16 v[30:31], v5 offset:45568
    v_mfma_f32_16x16x32_bf16 v[96:99], v[16:19], a[44:47], v[96:99]
    s_barrier
    ds_read_b128 a[48:51], v6 offset:49152
    ds_read_b128 a[52:55], v6 offset:51200
    ds_read_b64_tr_b16 v[16:17], v2 offset:49152
    v_mfma_f32_16x16x32_bf16 v[88:91], v[20:23], a[40:43], v[88:91]
    ds_read_b64_tr_b16 v[18:19], v2 offset:49664
    v_mfma_f32_16x16x32_bf16 v[104:107], v[20:23], a[44:47], v[104:107]
    ds_read_b64_tr_b16 v[20:21], v2 offset:57344
    s_waitcnt lgkmcnt(5)
    v_mfma_f32_16x16x32_bf16 v[84:87], v[24:27], a[40:43], v[84:87]
    ds_read_b64_tr_b16 v[22:23], v2 offset:57856
    v_mfma_f32_16x16x32_bf16 v[100:103], v[24:27], a[44:47], v[100:103]
    ds_read_b64_tr_b16 v[24:25], v3 offset:49152
    v_mfma_f32_16x16x32_bf16 v[92:95], v[28:31], a[40:43], v[92:95]
    ds_read_b64_tr_b16 v[26:27], v3 offset:49664
    v_mfma_f32_16x16x32_bf16 v[108:111], v[28:31], a[44:47], v[108:111]
    ds_read_b64_tr_b16 v[28:29], v3 offset:57344
    s_waitcnt lgkmcnt(3)
    v_mfma_f32_16x16x32_bf16 v[48:51], v[16:19], a[48:51], v[48:51]
    ds_read_b64_tr_b16 v[30:31], v3 offset:57856
    ds_read_b128 a[56:59], v1 offset:49152
    v_mfma_f32_16x16x32_bf16 v[64:67], v[16:19], a[52:55], v[64:67]
    ds_read_b64_tr_b16 v[16:17], v4 offset:49152
    v_mfma_f32_16x16x32_bf16 v[56:59], v[20:23], a[48:51], v[56:59]
    ds_read_b64_tr_b16 v[18:19], v4 offset:49664
    ds_read_b128 a[60:63], v1 offset:51200
    v_mfma_f32_16x16x32_bf16 v[72:75], v[20:23], a[52:55], v[72:75]
    ds_read_b64_tr_b16 v[20:21], v4 offset:57344
    s_waitcnt lgkmcnt(5)
    v_mfma_f32_16x16x32_bf16 v[52:55], v[24:27], a[48:51], v[52:55]
    ds_read_b64_tr_b16 v[22:23], v4 offset:57856
    v_mfma_f32_16x16x32_bf16 v[68:71], v[24:27], a[52:55], v[68:71]
    ds_read_b64_tr_b16 v[24:25], v5 offset:49152
    v_mfma_f32_16x16x32_bf16 v[60:63], v[28:31], a[48:51], v[60:63]
    ds_read_b64_tr_b16 v[26:27], v5 offset:49664
    v_mfma_f32_16x16x32_bf16 v[76:79], v[28:31], a[52:55], v[76:79]
    ds_read_b64_tr_b16 v[28:29], v5 offset:57344
    s_waitcnt lgkmcnt(3)
    v_mfma_f32_16x16x32_bf16 v[80:83], v[16:19], a[48:51], v[80:83]
    ds_read_b64_tr_b16 v[30:31], v5 offset:57856
    v_mfma_f32_16x16x32_bf16 v[96:99], v[16:19], a[52:55], v[96:99]
    ds_read_b64_tr_b16 v[16:17], v2 offset:53248
    v_mfma_f32_16x16x32_bf16 v[88:91], v[20:23], a[48:51], v[88:91]
    ds_read_b64_tr_b16 v[18:19], v2 offset:53760
    v_mfma_f32_16x16x32_bf16 v[104:107], v[20:23], a[52:55], v[104:107]
    ds_read_b64_tr_b16 v[20:21], v2 offset:61440
    s_waitcnt lgkmcnt(3)
    v_mfma_f32_16x16x32_bf16 v[84:87], v[24:27], a[48:51], v[84:87]
    ds_read_b64_tr_b16 v[22:23], v2 offset:61952
    v_mfma_f32_16x16x32_bf16 v[100:103], v[24:27], a[52:55], v[100:103]
    ds_read_b64_tr_b16 v[24:25], v3 offset:53248
    v_mfma_f32_16x16x32_bf16 v[92:95], v[28:31], a[48:51], v[92:95]
    ds_read_b64_tr_b16 v[26:27], v3 offset:53760
    v_mfma_f32_16x16x32_bf16 v[108:111], v[28:31], a[52:55], v[108:111]
    ds_read_b64_tr_b16 v[28:29], v3 offset:61440
    s_waitcnt lgkmcnt(3)
    v_mfma_f32_16x16x32_bf16 v[48:51], v[16:19], a[56:59], v[48:51]
    ds_read_b64_tr_b16 v[30:31], v3 offset:61952
    v_mfma_f32_16x16x32_bf16 v[64:67], v[16:19], a[60:63], v[64:67]
    ds_read_b64_tr_b16 v[16:17], v4 offset:53248
    v_mfma_f32_16x16x32_bf16 v[56:59], v[20:23], a[56:59], v[56:59]
    ds_read_b64_tr_b16 v[18:19], v4 offset:53760
    v_mfma_f32_16x16x32_bf16 v[72:75], v[20:23], a[60:63], v[72:75]
    ds_read_b64_tr_b16 v[20:21], v4 offset:61440
    s_waitcnt lgkmcnt(3)
    v_mfma_f32_16x16x32_bf16 v[52:55], v[24:27], a[56:59], v[52:55]
    ds_read_b64_tr_b16 v[22:23], v4 offset:61952
    v_mfma_f32_16x16x32_bf16 v[68:71], v[24:27], a[60:63], v[68:71]
    ds_read_b64_tr_b16 v[24:25], v5 offset:53248
    v_mfma_f32_16x16x32_bf16 v[60:63], v[28:31], a[56:59], v[60:63]
    ds_read_b64_tr_b16 v[26:27], v5 offset:53760
    v_mfma_f32_16x16x32_bf16 v[76:79], v[28:31], a[60:63], v[76:79]
    ds_read_b64_tr_b16 v[28:29], v5 offset:61440
    s_waitcnt lgkmcnt(3)
    v_mfma_f32_16x16x32_bf16 v[80:83], v[16:19], a[56:59], v[80:83]
    ds_read_b64_tr_b16 v[30:31], v5 offset:61952
    v_mfma_f32_16x16x32_bf16 v[96:99], v[16:19], a[60:63], v[96:99]
    s_barrier
    ds_read_b128 a[64:67], v6 offset:0
    ds_read_b128 a[68:71], v6 offset:2048
    ds_read_b64_tr_b16 v[16:17], v2 offset:0
    v_mfma_f32_16x16x32_bf16 v[88:91], v[20:23], a[56:59], v[88:91]
    ds_read_b64_tr_b16 v[18:19], v2 offset:512
    v_mfma_f32_16x16x32_bf16 v[104:107], v[20:23], a[60:63], v[104:107]
    ds_read_b64_tr_b16 v[20:21], v2 offset:8192
    s_waitcnt lgkmcnt(5)
    v_mfma_f32_16x16x32_bf16 v[84:87], v[24:27], a[56:59], v[84:87]
    ds_read_b64_tr_b16 v[22:23], v2 offset:8704
    v_mfma_f32_16x16x32_bf16 v[100:103], v[24:27], a[60:63], v[100:103]
    ds_read_b64_tr_b16 v[24:25], v3 offset:0
    v_mfma_f32_16x16x32_bf16 v[92:95], v[28:31], a[56:59], v[92:95]
    ds_read_b64_tr_b16 v[26:27], v3 offset:512
    v_mfma_f32_16x16x32_bf16 v[108:111], v[28:31], a[60:63], v[108:111]
    ds_read_b64_tr_b16 v[28:29], v3 offset:8192
    s_waitcnt lgkmcnt(3)
    v_mfma_f32_16x16x32_bf16 v[48:51], v[16:19], a[64:67], v[48:51]
    ds_read_b64_tr_b16 v[30:31], v3 offset:8704
    ds_read_b128 a[72:75], v1 offset:0
    v_mfma_f32_16x16x32_bf16 v[64:67], v[16:19], a[68:71], v[64:67]
    ds_read_b64_tr_b16 v[16:17], v4 offset:0
    v_mfma_f32_16x16x32_bf16 v[56:59], v[20:23], a[64:67], v[56:59]
    ds_read_b64_tr_b16 v[18:19], v4 offset:512
    ds_read_b128 a[76:79], v1 offset:2048
    v_mfma_f32_16x16x32_bf16 v[72:75], v[20:23], a[68:71], v[72:75]
    ds_read_b64_tr_b16 v[20:21], v4 offset:8192
    s_waitcnt lgkmcnt(5)
    v_mfma_f32_16x16x32_bf16 v[52:55], v[24:27], a[64:67], v[52:55]
    ds_read_b64_tr_b16 v[22:23], v4 offset:8704
    v_mfma_f32_16x16x32_bf16 v[68:71], v[24:27], a[68:71], v[68:71]
    ds_read_b64_tr_b16 v[24:25], v5 offset:0
    v_mfma_f32_16x16x32_bf16 v[60:63], v[28:31], a[64:67], v[60:63]
    ds_read_b64_tr_b16 v[26:27], v5 offset:512
    v_mfma_f32_16x16x32_bf16 v[76:79], v[28:31], a[68:71], v[76:79]
    ds_read_b64_tr_b16 v[28:29], v5 offset:8192
    s_waitcnt lgkmcnt(3)
    v_mfma_f32_16x16x32_bf16 v[80:83], v[16:19], a[64:67], v[80:83]
    ds_read_b64_tr_b16 v[30:31], v5 offset:8704
    v_mfma_f32_16x16x32_bf16 v[96:99], v[16:19], a[68:71], v[96:99]
    ds_read_b64_tr_b16 v[16:17], v2 offset:4096
    v_mfma_f32_16x16x32_bf16 v[88:91], v[20:23], a[64:67], v[88:91]
    ds_read_b64_tr_b16 v[18:19], v2 offset:4608
    v_mfma_f32_16x16x32_bf16 v[104:107], v[20:23], a[68:71], v[104:107]
    ds_read_b64_tr_b16 v[20:21], v2 offset:12288
    s_waitcnt lgkmcnt(3)
    v_mfma_f32_16x16x32_bf16 v[84:87], v[24:27], a[64:67], v[84:87]
    ds_read_b64_tr_b16 v[22:23], v2 offset:12800
    v_mfma_f32_16x16x32_bf16 v[100:103], v[24:27], a[68:71], v[100:103]
    ds_read_b64_tr_b16 v[24:25], v3 offset:4096
    v_mfma_f32_16x16x32_bf16 v[92:95], v[28:31], a[64:67], v[92:95]
    ds_read_b64_tr_b16 v[26:27], v3 offset:4608
    v_mfma_f32_16x16x32_bf16 v[108:111], v[28:31], a[68:71], v[108:111]
    ds_read_b64_tr_b16 v[28:29], v3 offset:12288
    s_waitcnt lgkmcnt(3)
    v_mfma_f32_16x16x32_bf16 v[48:51], v[16:19], a[72:75], v[48:51]
    ds_read_b64_tr_b16 v[30:31], v3 offset:12800
    v_mfma_f32_16x16x32_bf16 v[64:67], v[16:19], a[76:79], v[64:67]
    ds_read_b64_tr_b16 v[16:17], v4 offset:4096
    v_mfma_f32_16x16x32_bf16 v[56:59], v[20:23], a[72:75], v[56:59]
    ds_read_b64_tr_b16 v[18:19], v4 offset:4608
    v_mfma_f32_16x16x32_bf16 v[72:75], v[20:23], a[76:79], v[72:75]
    ds_read_b64_tr_b16 v[20:21], v4 offset:12288
    s_waitcnt lgkmcnt(3)
    v_mfma_f32_16x16x32_bf16 v[52:55], v[24:27], a[72:75], v[52:55]
    ds_read_b64_tr_b16 v[22:23], v4 offset:12800
    v_mfma_f32_16x16x32_bf16 v[68:71], v[24:27], a[76:79], v[68:71]
    ds_read_b64_tr_b16 v[24:25], v5 offset:4096
    v_mfma_f32_16x16x32_bf16 v[60:63], v[28:31], a[72:75], v[60:63]
    ds_read_b64_tr_b16 v[26:27], v5 offset:4608
    v_mfma_f32_16x16x32_bf16 v[76:79], v[28:31], a[76:79], v[76:79]
    ds_read_b64_tr_b16 v[28:29], v5 offset:12288
    s_waitcnt lgkmcnt(3)
    v_mfma_f32_16x16x32_bf16 v[80:83], v[16:19], a[72:75], v[80:83]
    ds_read_b64_tr_b16 v[30:31], v5 offset:12800
    v_mfma_f32_16x16x32_bf16 v[96:99], v[16:19], a[76:79], v[96:99]
    s_barrier
    ds_read_b128 a[80:83], v6 offset:16384
    ds_read_b128 a[84:87], v6 offset:18432
    ds_read_b64_tr_b16 v[16:17], v2 offset:16384
    v_mfma_f32_16x16x32_bf16 v[88:91], v[20:23], a[72:75], v[88:91]
    ds_read_b64_tr_b16 v[18:19], v2 offset:16896
    v_mfma_f32_16x16x32_bf16 v[104:107], v[20:23], a[76:79], v[104:107]
    ds_read_b64_tr_b16 v[20:21], v2 offset:24576
    s_waitcnt lgkmcnt(5)
    v_mfma_f32_16x16x32_bf16 v[84:87], v[24:27], a[72:75], v[84:87]
    ds_read_b64_tr_b16 v[22:23], v2 offset:25088
    v_mfma_f32_16x16x32_bf16 v[100:103], v[24:27], a[76:79], v[100:103]
    ds_read_b64_tr_b16 v[24:25], v3 offset:16384
    v_mfma_f32_16x16x32_bf16 v[92:95], v[28:31], a[72:75], v[92:95]
    ds_read_b64_tr_b16 v[26:27], v3 offset:16896
    v_mfma_f32_16x16x32_bf16 v[108:111], v[28:31], a[76:79], v[108:111]
    ds_read_b64_tr_b16 v[28:29], v3 offset:24576
    s_waitcnt lgkmcnt(3)
    v_mfma_f32_16x16x32_bf16 v[48:51], v[16:19], a[80:83], v[48:51]
    ds_read_b64_tr_b16 v[30:31], v3 offset:25088
    ds_read_b128 a[88:91], v1 offset:16384
    v_mfma_f32_16x16x32_bf16 v[64:67], v[16:19], a[84:87], v[64:67]
    ds_read_b64_tr_b16 v[16:17], v4 offset:16384
    v_mfma_f32_16x16x32_bf16 v[56:59], v[20:23], a[80:83], v[56:59]
    ds_read_b64_tr_b16 v[18:19], v4 offset:16896
    ds_read_b128 a[92:95], v1 offset:18432
    v_mfma_f32_16x16x32_bf16 v[72:75], v[20:23], a[84:87], v[72:75]
    ds_read_b64_tr_b16 v[20:21], v4 offset:24576
    s_waitcnt lgkmcnt(5)
    v_mfma_f32_16x16x32_bf16 v[52:55], v[24:27], a[80:83], v[52:55]
    ds_read_b64_tr_b16 v[22:23], v4 offset:25088
    v_mfma_f32_16x16x32_bf16 v[68:71], v[24:27], a[84:87], v[68:71]
    ds_read_b64_tr_b16 v[24:25], v5 offset:16384
    v_mfma_f32_16x16x32_bf16 v[60:63], v[28:31], a[80:83], v[60:63]
    ds_read_b64_tr_b16 v[26:27], v5 offset:16896
    v_mfma_f32_16x16x32_bf16 v[76:79], v[28:31], a[84:87], v[76:79]
    ds_read_b64_tr_b16 v[28:29], v5 offset:24576
    s_waitcnt lgkmcnt(3)
    v_mfma_f32_16x16x32_bf16 v[80:83], v[16:19], a[80:83], v[80:83]
    ds_read_b64_tr_b16 v[30:31], v5 offset:25088
    v_mfma_f32_16x16x32_bf16 v[96:99], v[16:19], a[84:87], v[96:99]
    ds_read_b64_tr_b16 v[16:17], v2 offset:20480
    v_mfma_f32_16x16x32_bf16 v[88:91], v[20:23], a[80:83], v[88:91]
    ds_read_b64_tr_b16 v[18:19], v2 offset:20992
    v_mfma_f32_16x16x32_bf16 v[104:107], v[20:23], a[84:87], v[104:107]
    ds_read_b64_tr_b16 v[20:21], v2 offset:28672
    s_waitcnt lgkmcnt(3)
    v_mfma_f32_16x16x32_bf16 v[84:87], v[24:27], a[80:83], v[84:87]
    ds_read_b64_tr_b16 v[22:23], v2 offset:29184
    v_mfma_f32_16x16x32_bf16 v[100:103], v[24:27], a[84:87], v[100:103]
    ds_read_b64_tr_b16 v[24:25], v3 offset:20480
    v_mfma_f32_16x16x32_bf16 v[92:95], v[28:31], a[80:83], v[92:95]
    ds_read_b64_tr_b16 v[26:27], v3 offset:20992
    v_mfma_f32_16x16x32_bf16 v[108:111], v[28:31], a[84:87], v[108:111]
    ds_read_b64_tr_b16 v[28:29], v3 offset:28672
    s_waitcnt lgkmcnt(3)
    v_mfma_f32_16x16x32_bf16 v[48:51], v[16:19], a[88:91], v[48:51]
    ds_read_b64_tr_b16 v[30:31], v3 offset:29184
    v_mfma_f32_16x16x32_bf16 v[64:67], v[16:19], a[92:95], v[64:67]
    ds_read_b64_tr_b16 v[16:17], v4 offset:20480
    v_mfma_f32_16x16x32_bf16 v[56:59], v[20:23], a[88:91], v[56:59]
    ds_read_b64_tr_b16 v[18:19], v4 offset:20992
    v_mfma_f32_16x16x32_bf16 v[72:75], v[20:23], a[92:95], v[72:75]
    ds_read_b64_tr_b16 v[20:21], v4 offset:28672
    s_waitcnt lgkmcnt(3)
    v_mfma_f32_16x16x32_bf16 v[52:55], v[24:27], a[88:91], v[52:55]
    ds_read_b64_tr_b16 v[22:23], v4 offset:29184
    v_mfma_f32_16x16x32_bf16 v[68:71], v[24:27], a[92:95], v[68:71]
    ds_read_b64_tr_b16 v[24:25], v5 offset:20480
    v_mfma_f32_16x16x32_bf16 v[60:63], v[28:31], a[88:91], v[60:63]
    ds_read_b64_tr_b16 v[26:27], v5 offset:20992
    v_mfma_f32_16x16x32_bf16 v[76:79], v[28:31], a[92:95], v[76:79]
    ds_read_b64_tr_b16 v[28:29], v5 offset:28672
    s_waitcnt lgkmcnt(3)
    v_mfma_f32_16x16x32_bf16 v[80:83], v[16:19], a[88:91], v[80:83]
    ds_read_b64_tr_b16 v[30:31], v5 offset:29184
    v_mfma_f32_16x16x32_bf16 v[96:99], v[16:19], a[92:95], v[96:99]
    s_barrier
    ds_read_b128 a[96:99], v6 offset:32768
    ds_read_b128 a[100:103], v6 offset:34816
    ds_read_b64_tr_b16 v[16:17], v2 offset:32768
    v_mfma_f32_16x16x32_bf16 v[88:91], v[20:23], a[88:91], v[88:91]
    ds_read_b64_tr_b16 v[18:19], v2 offset:33280
    v_mfma_f32_16x16x32_bf16 v[104:107], v[20:23], a[92:95], v[104:107]
    ds_read_b64_tr_b16 v[20:21], v2 offset:40960
    s_waitcnt lgkmcnt(5)
    v_mfma_f32_16x16x32_bf16 v[84:87], v[24:27], a[88:91], v[84:87]
    ds_read_b64_tr_b16 v[22:23], v2 offset:41472
    v_mfma_f32_16x16x32_bf16 v[100:103], v[24:27], a[92:95], v[100:103]
    ds_read_b64_tr_b16 v[24:25], v3 offset:32768
    v_mfma_f32_16x16x32_bf16 v[92:95], v[28:31], a[88:91], v[92:95]
    ds_read_b64_tr_b16 v[26:27], v3 offset:33280
    v_mfma_f32_16x16x32_bf16 v[108:111], v[28:31], a[92:95], v[108:111]
    ds_read_b64_tr_b16 v[28:29], v3 offset:40960
    s_waitcnt lgkmcnt(3)
    v_mfma_f32_16x16x32_bf16 v[48:51], v[16:19], a[96:99], v[48:51]
    ds_read_b64_tr_b16 v[30:31], v3 offset:41472
    ds_read_b128 a[104:107], v1 offset:32768
    v_mfma_f32_16x16x32_bf16 v[64:67], v[16:19], a[100:103], v[64:67]
    ds_read_b64_tr_b16 v[16:17], v4 offset:32768
    v_mfma_f32_16x16x32_bf16 v[56:59], v[20:23], a[96:99], v[56:59]
    ds_read_b64_tr_b16 v[18:19], v4 offset:33280
    ds_read_b128 a[108:111], v1 offset:34816
    v_mfma_f32_16x16x32_bf16 v[72:75], v[20:23], a[100:103], v[72:75]
    ds_read_b64_tr_b16 v[20:21], v4 offset:40960
    s_waitcnt lgkmcnt(5)
    s_branch L_skippad1
.p2align 12
L_pad1:
    s_setpc_b64 s[50:51]
L_skippad1:
    v_mfma_f32_16x16x32_bf16 v[52:55], v[24:27], a[96:99], v[52:55]
    ds_read_b64_tr_b16 v[22:23], v4 offset:41472
    v_mfma_f32_16x16x32_bf16 v[68:71], v[24:27], a[100:103], v[68:71]
    ds_read_b64_tr_b16 v[24:25], v5 offset:32768
    v_mfma_f32_16x16x32_bf16 v[60:63], v[28:31], a[96:99], v[60:63]
    ds_read_b64_tr_b16 v[26:27], v5 offset:33280
    v_mfma_f32_16x16x32_bf16 v[76:79], v[28:31], a[100:103], v[76:79]
    ds_read_b64_tr_b16 v[28:29], v5 offset:40960
    s_waitcnt lgkmcnt(3)
    v_mfma_f32_16x16x32_bf16 v[80:83], v[16:19], a[96:99], v[80:83]
    ds_read_b64_tr_b16 v[30:31], v5 offset:41472
    v_mfma_f32_16x16x32_bf16 v[96:99], v[16:19], a[100:103], v[96:99]
    ds_read_b64_tr_b16 v[16:17], v2 offset:36864
    v_mfma_f32_16x16x32_bf16 v[88:91], v[20:23], a[96:99], v[88:91]
    ds_read_b64_tr_b16 v[18:19], v2 offset:37376
    v_mfma_f32_16x16x32_bf16 v[104:107], v[20:23], a[100:103], v[104:107]
    ds_read_b64_tr_b16 v[20:21], v2 offset:45056
    s_waitcnt lgkmcnt(3)
    v_mfma_f32_16x16x32_bf16 v[84:87], v[24:27], a[96:99], v[84:87]
    ds_read_b64_tr_b16 v[22:23], v2 offset:45568
    v_mfma_f32_16x16x32_bf16 v[100:103], v[24:27], a[100:103], v[100:103]
    ds_read_b64_tr_b16 v[24:25], v3 offset:36864
    v_mfma_f32_16x16x32_bf16 v[92:95], v[28:31], a[96:99], v[92:95]
    ds_read_b64_tr_b16 v[26:27], v3 offset:37376
    v_mfma_f32_16x16x32_bf16 v[108:111], v[28:31], a[100:103], v[108:111]
    ds_read_b64_tr_b16 v[28:29], v3 offset:45056
    s_waitcnt lgkmcnt(3)
    v_mfma_f32_16x16x32_bf16 v[48:51], v[16:19], a[104:107], v[48:51]
    ds_read_b64_tr_b16 v[30:31], v3 offset:45568
    v_mfma_f32_16x16x32_bf16 v[64:67], v[16:19], a[108:111], v[64:67]
    ds_read_b64_tr_b16 v[16:17], v4 offset:36864
    v_mfma_f32_16x16x32_bf16 v[56:59], v[20:23], a[104:107], v[56:59]
    ds_read_b64_tr_b16 v[18:19], v4 offset:37376
    v_mfma_f32_16x16x32_bf16 v[72:75], v[20:23], a[108:111], v[72:75]
    ds_read_b64_tr_b16 v[20:21], v4 offset:45056
    s_waitcnt lgkmcnt(3)
    v_mfma_f32_16x16x32_bf16 v[52:55], v[24:27], a[104:107], v[52:55]
    ds_read_b64_tr_b16 v[22:23], v4 offset:45568
    v_mfma_f32_16x16x32_bf16 v[68:71], v[24:27], a[108:111], v[68:71]
    ds_read_b64_tr_b16 v[24:25], v5 offset:36864
    v_mfma_f32_16x16x32_bf16 v[60:63], v[28:31], a[104:107], v[60:63]
    ds_read_b64_tr_b16 v[26:27], v5 offset:37376
    v_mfma_f32_16x16x32_bf16 v[76:79], v[28:31], a[108:111], v[76:79]
    ds_read_b64_tr_b16 v[28:29], v5 offset:45056
    s_waitcnt lgkmcnt(3)
    v_mfma_f32_16x16x32_bf16 v[80:83], v[16:19], a[104:107], v[80:83]
    ds_read_b64_tr_b16 v[30:31], v5 offset:45568
    v_mfma_f32_16x16x32_bf16 v[96:99], v[16:19], a[108:111], v[96:99]
    s_barrier
    ds_read_b128 a[112:115], v6 offset:49152
    ds_read_b128 a[116:119], v6 offset:51200
    ds_read_b64_tr_b16 v[16:17], v2 offset:49152
    v_mfma_f32_16x16x32_bf16 v[88:91], v[20:23], a[104:107], v[88:91]
    ds_read_b64_tr_b16 v[18:19], v2 offset:49664
    v_mfma_f32_16x16x32_bf16 v[104:107], v[20:23], a[108:111], v[104:107]
    ds_read_b64_tr_b16 v[20:21], v2 offset:57344
    s_waitcnt lgkmcnt(5)
    v_mfma_f32_16x16x32_bf16 v[84:87], v[24:27], a[104:107], v[84:87]
    ds_read_b64_tr_b16 v[22:23], v2 offset:57856
    v_mfma_f32_16x16x32_bf16 v[100:103], v[24:27], a[108:111], v[100:103]
    ds_read_b64_tr_b16 v[24:25], v3 offset:49152
    v_mfma_f32_16x16x32_bf16 v[92:95], v[28:31], a[104:107], v[92:95]
    ds_read_b64_tr_b16 v[26:27], v3 offset:49664
    v_mfma_f32_16x16x32_bf16 v[108:111], v[28:31], a[108:111], v[108:111]
    ds_read_b64_tr_b16 v[28:29], v3 offset:57344
    s_waitcnt lgkmcnt(3)
    v_mfma_f32_16x16x32_bf16 v[48:51], v[16:19], a[112:115], v[48:51]
    ds_read_b64_tr_b16 v[30:31], v3 offset:57856
    ds_read_b128 a[120:123], v1 offset:49152
    v_mfma_f32_16x16x32_bf16 v[64:67], v[16:19], a[116:119], v[64:67]
    ds_read_b64_tr_b16 v[16:17], v4 offset:49152
    v_mfma_f32_16x16x32_bf16 v[56:59], v[20:23], a[112:115], v[56:59]
    ds_read_b64_tr_b16 v[18:19], v4 offset:49664
    ds_read_b128 a[124:127], v1 offset:51200
    v_mfma_f32_16x16x32_bf16 v[72:75], v[20:23], a[116:119], v[72:75]
    ds_read_b64_tr_b16 v[20:21], v4 offset:57344
    s_waitcnt lgkmcnt(5)
    v_mfma_f32_16x16x32_bf16 v[52:55], v[24:27], a[112:115], v[52:55]
    ds_read_b64_tr_b16 v[22:23], v4 offset:57856
    v_mfma_f32_16x16x32_bf16 v[68:71], v[24:27], a[116:119], v[68:71]
    ds_read_b64_tr_b16 v[24:25], v5 offset:49152
    v_mfma_f32_16x16x32_bf16 v[60:63], v[28:31], a[112:115], v[60:63]
    ds_read_b64_tr_b16 v[26:27], v5 offset:49664
    v_mfma_f32_16x16x32_bf16 v[76:79], v[28:31], a[116:119], v[76:79]
    ds_read_b64_tr_b16 v[28:29], v5 offset:57344
    s_waitcnt lgkmcnt(3)
    v_mfma_f32_16x16x32_bf16 v[80:83], v[16:19], a[112:115], v[80:83]
    ds_read_b64_tr_b16 v[30:31], v5 offset:57856
    v_mfma_f32_16x16x32_bf16 v[96:99], v[16:19], a[116:119], v[96:99]
    ds_read_b64_tr_b16 v[16:17], v2 offset:53248
    v_mfma_f32_16x16x32_bf16 v[88:91], v[20:23], a[112:115], v[88:91]
    ds_read_b64_tr_b16 v[18:19], v2 offset:53760
    v_mfma_f32_16x16x32_bf16 v[104:107], v[20:23], a[116:119], v[104:107]
    ds_read_b64_tr_b16 v[20:21], v2 offset:61440
    s_waitcnt lgkmcnt(3)
    v_mfma_f32_16x16x32_bf16 v[84:87], v[24:27], a[112:115], v[84:87]
    ds_read_b64_tr_b16 v[22:23], v2 offset:61952
    v_mfma_f32_16x16x32_bf16 v[100:103], v[24:27], a[116:119], v[100:103]
    ds_read_b64_tr_b16 v[24:25], v3 offset:53248
    v_mfma_f32_16x16x32_bf16 v[92:95], v[28:31], a[112:115], v[92:95]
    ds_read_b64_tr_b16 v[26:27], v3 offset:53760
    v_mfma_f32_16x16x32_bf16 v[108:111], v[28:31], a[116:119], v[108:111]
    ds_read_b64_tr_b16 v[28:29], v3 offset:61440
    s_waitcnt lgkmcnt(3)
    v_mfma_f32_16x16x32_bf16 v[48:51], v[16:19], a[120:123], v[48:51]
    ds_read_b64_tr_b16 v[30:31], v3 offset:61952
    v_mfma_f32_16x16x32_bf16 v[64:67], v[16:19], a[124:127], v[64:67]
    ds_read_b64_tr_b16 v[16:17], v4 offset:53248
    v_mfma_f32_16x16x32_bf16 v[56:59], v[20:23], a[120:123], v[56:59]
    ds_read_b64_tr_b16 v[18:19], v4 offset:53760
    v_mfma_f32_16x16x32_bf16 v[72:75], v[20:23], a[124:127], v[72:75]
    ds_read_b64_tr_b16 v[20:21], v4 offset:61440
    s_waitcnt lgkmcnt(3)
    v_mfma_f32_16x16x32_bf16 v[52:55], v[24:27], a[120:123], v[52:55]
    ds_read_b64_tr_b16 v[22:23], v4 offset:61952
    v_mfma_f32_16x16x32_bf16 v[68:71], v[24:27], a[124:127], v[68:71]
    ds_read_b64_tr_b16 v[24:25], v5 offset:53248
    v_mfma_f32_16x16x32_bf16 v[60:63], v[28:31], a[120:123], v[60:63]
    ds_read_b64_tr_b16 v[26:27], v5 offset:53760
    v_mfma_f32_16x16x32_bf16 v[76:79], v[28:31], a[124:127], v[76:79]
    ds_read_b64_tr_b16 v[28:29], v5 offset:61440
    s_waitcnt lgkmcnt(3)
    v_mfma_f32_16x16x32_bf16 v[80:83], v[16:19], a[120:123], v[80:83]
    ds_read_b64_tr_b16 v[30:31], v5 offset:61952
    v_mfma_f32_16x16x32_bf16 v[96:99], v[16:19], a[124:127], v[96:99]
    s_barrier
    ds_read_b128 a[128:131], v6 offset:0
    ds_read_b128 a[132:135], v6 offset:2048
    ds_read_b64_tr_b16 v[16:17], v2 offset:0
    v_mfma_f32_16x16x32_bf16 v[88:91], v[20:23], a[120:123], v[88:91]
    ds_read_b64_tr_b16 v[18:19], v2 offset:512
    v_mfma_f32_16x16x32_bf16 v[104:107], v[20:23], a[124:127], v[104:107]
    ds_read_b64_tr_b16 v[20:21], v2 offset:8192
    s_waitcnt lgkmcnt(5)
    v_mfma_f32_16x16x32_bf16 v[84:87], v[24:27], a[120:123], v[84:87]
    ds_read_b64_tr_b16 v[22:23], v2 offset:8704
    v_mfma_f32_16x16x32_bf16 v[100:103], v[24:27], a[124:127], v[100:103]
    ds_read_b64_tr_b16 v[24:25], v3 offset:0
    v_mfma_f32_16x16x32_bf16 v[92:95], v[28:31], a[120:123], v[92:95]
    ds_read_b64_tr_b16 v[26:27], v3 offset:512
    v_mfma_f32_16x16x32_bf16 v[108:111], v[28:31], a[124:127], v[108:111]
    ds_read_b64_tr_b16 v[28:29], v3 offset:8192
    s_waitcnt lgkmcnt(3)
    v_mfma_f32_16x16x32_bf16 v[48:51], v[16:19], a[128:131], v[48:51]
    ds_read_b64_tr_b16 v[30:31], v3 offset:8704
    ds_read_b128 a[136:139], v1 offset:0
    v_mfma_f32_16x16x32_bf16 v[64:67], v[16:19], a[132:135], v[64:67]
    ds_read_b64_tr_b16 v[16:17], v4 offset:0
    v_mfma_f32_16x16x32_bf16 v[56:59], v[20:23], a[128:131], v[56:59]
    ds_read_b64_tr_b16 v[18:19], v4 offset:512
    ds_read_b128 a[140:143], v1 offset:2048
    v_mfma_f32_16x16x32_bf16 v[72:75], v[20:23], a[132:135], v[72:75]
    ds_read_b64_tr_b16 v[20:21], v4 offset:8192
    s_waitcnt lgkmcnt(5)
    v_mfma_f32_16x16x32_bf16 v[52:55], v[24:27], a[128:131], v[52:55]
    ds_read_b64_tr_b16 v[22:23], v4 offset:8704
    v_mfma_f32_16x16x32_bf16 v[68:71], v[24:27], a[132:135], v[68:71]
    ds_read_b64_tr_b16 v[24:25], v5 offset:0
    v_mfma_f32_16x16x32_bf16 v[60:63], v[28:31], a[128:131], v[60:63]
    ds_read_b64_tr_b16 v[26:27], v5 offset:512
    v_mfma_f32_16x16x32_bf16 v[76:79], v[28:31], a[132:135], v[76:79]
    ds_read_b64_tr_b16 v[28:29], v5 offset:8192
    s_waitcnt lgkmcnt(3)
    v_mfma_f32_16x16x32_bf16 v[80:83], v[16:19], a[128:131], v[80:83]
    ds_read_b64_tr_b16 v[30:31], v5 offset:8704
    v_mfma_f32_16x16x32_bf16 v[96:99], v[16:19], a[132:135], v[96:99]
    ds_read_b64_tr_b16 v[16:17], v2 offset:4096
    v_mfma_f32_16x16x32_bf16 v[88:91], v[20:23], a[128:131], v[88:91]
    ds_read_b64_tr_b16 v[18:19], v2 offset:4608
    v_mfma_f32_16x16x32_bf16 v[104:107], v[20:23], a[132:135], v[104:107]
    ds_read_b64_tr_b16 v[20:21], v2 offset:12288
    s_waitcnt lgkmcnt(3)
    v_mfma_f32_16x16x32_bf16 v[84:87], v[24:27], a[128:131], v[84:87]
    ds_read_b64_tr_b16 v[22:23], v2 offset:12800
    v_mfma_f32_16x16x32_bf16 v[100:103], v[24:27], a[132:135], v[100:103]
    ds_read_b64_tr_b16 v[24:25], v3 offset:4096
    v_mfma_f32_16x16x32_bf16 v[92:95], v[28:31], a[128:131], v[92:95]
    ds_read_b64_tr_b16 v[26:27], v3 offset:4608
    v_mfma_f32_16x16x32_bf16 v[108:111], v[28:31], a[132:135], v[108:111]
    ds_read_b64_tr_b16 v[28:29], v3 offset:12288
    s_waitcnt lgkmcnt(3)
    v_mfma_f32_16x16x32_bf16 v[48:51], v[16:19], a[136:139], v[48:51]
    ds_read_b64_tr_b16 v[30:31], v3 offset:12800
    v_mfma_f32_16x16x32_bf16 v[64:67], v[16:19], a[140:143], v[64:67]
    ds_read_b64_tr_b16 v[16:17], v4 offset:4096
    v_mfma_f32_16x16x32_bf16 v[56:59], v[20:23], a[136:139], v[56:59]
    ds_read_b64_tr_b16 v[18:19], v4 offset:4608
    v_mfma_f32_16x16x32_bf16 v[72:75], v[20:23], a[140:143], v[72:75]
    ds_read_b64_tr_b16 v[20:21], v4 offset:12288
    s_waitcnt lgkmcnt(3)
    v_mfma_f32_16x16x32_bf16 v[52:55], v[24:27], a[136:139], v[52:55]
    ds_read_b64_tr_b16 v[22:23], v4 offset:12800
    v_mfma_f32_16x16x32_bf16 v[68:71], v[24:27], a[140:143], v[68:71]
    ds_read_b64_tr_b16 v[24:25], v5 offset:4096
    v_mfma_f32_16x16x32_bf16 v[60:63], v[28:31], a[136:139], v[60:63]
    ds_read_b64_tr_b16 v[26:27], v5 offset:4608
    v_mfma_f32_16x16x32_bf16 v[76:79], v[28:31], a[140:143], v[76:79]
    ds_read_b64_tr_b16 v[28:29], v5 offset:12288
    s_waitcnt lgkmcnt(3)
    v_mfma_f32_16x16x32_bf16 v[80:83], v[16:19], a[136:139], v[80:83]
    ds_read_b64_tr_b16 v[30:31], v5 offset:12800
    v_mfma_f32_16x16x32_bf16 v[96:99], v[16:19], a[140:143], v[96:99]
    v_mfma_f32_16x16x32_bf16 v[88:91], v[20:23], a[136:139], v[88:91]
    v_mfma_f32_16x16x32_bf16 v[104:107], v[20:23], a[140:143], v[104:107]
    s_waitcnt lgkmcnt(0)
    v_mfma_f32_16x16x32_bf16 v[84:87], v[24:27], a[136:139], v[84:87]
    v_mfma_f32_16x16x32_bf16 v[100:103], v[24:27], a[140:143], v[100:103]
    v_mfma_f32_16x16x32_bf16 v[92:95], v[28:31], a[136:139], v[92:95]
    v_mfma_f32_16x16x32_bf16 v[108:111], v[28:31], a[140:143], v[108:111]
    s_setprio 3
    s_waitcnt vmcnt(0) lgkmcnt(0)
    s_add_u32 s64, s64, 0x9e3779b9
    v_lshlrev_b32 v1, 4, v0
    v_pk_mul_f32 v[8:9], v[48:49], v[48:49]
    v_pk_mul_f32 v[10:11], v[50:51], v[50:51]
    v_pk_mul_f32 v[12:13], v[52:53], v[52:53]
    v_pk_mul_f32 v[14:15], v[54:55], v[54:55]
    v_pk_fma_f32 v[8:9], v[8:9], s[56:57], v[6:7] op_sel:[0,0,1]
    v_pk_fma_f32 v[10:11], v[10:11], s[56:57], v[6:7] op_sel:[0,0,1]
    v_pk_fma_f32 v[12:13], v[12:13], s[56:57], v[6:7] op_sel:[0,0,1]
    v_pk_fma_f32 v[14:15], v[14:15], s[56:57], v[6:7] op_sel:[0,0,1]
    v_pk_mul_f32 v[8:9], v[8:9], v[48:49]
    v_pk_mul_f32 v[10:11], v[10:11], v[50:51]
    v_pk_mul_f32 v[12:13], v[12:13], v[52:53]
    v_pk_mul_f32 v[14:15], v[14:15], v[54:55]
    v_exp_f32 v8, v8
    v_exp_f32 v9, v9
    v_exp_f32 v10, v10
    v_exp_f32 v11, v11
    v_exp_f32 v12, v12
    v_exp_f32 v13, v13
    v_exp_f32 v14, v14
    v_exp_f32 v15, v15
    v_pk_add_f32 v[8:9], v[8:9], 1.0 op_sel_hi:[1,0]
    v_pk_add_f32 v[10:11], v[10:11], 1.0 op_sel_hi:[1,0]
    v_pk_add_f32 v[12:13], v[12:13], 1.0 op_sel_hi:[1,0]
    v_pk_add_f32 v[14:15], v[14:15], 1.0 op_sel_hi:[1,0]
    v_rcp_f32 v8, v8
    v_rcp_f32 v9, v9
    v_rcp_f32 v10, v10
    v_rcp_f32 v11, v11
    v_rcp_f32 v12, v12
    v_rcp_f32 v13, v13
    v_rcp_f32 v14, v14
    v_rcp_f32 v15, v15
    v_pk_mul_f32 v[8:9], v[8:9], v[48:49]
    v_pk_mul_f32 v[10:11], v[10:11], v[50:51]
    v_pk_mul_f32 v[12:13], v[12:13], v[52:53]
    v_pk_mul_f32 v[14:15], v[14:15], v[54:55]
    v_pk_mul_f32 v[8:9], v[8:9], v[56:57]
    v_pk_mul_f32 v[10:11], v[10:11], v[58:59]
    v_pk_mul_f32 v[12:13], v[12:13], v[60:61]
    v_pk_mul_f32 v[14:15], v[14:15], v[62:63]
    v_cvt_pk_bf16_f32 v32, v8, v9
    v_cvt_pk_bf16_f32 v33, v10, v11
    v_cvt_pk_bf16_f32 v34, v12, v13
    v_cvt_pk_bf16_f32 v35, v14, v15
    v_pk_mul_f32 v[8:9], v[64:65], v[64:65]
    v_pk_mul_f32 v[10:11], v[66:67], v[66:67]
    v_pk_mul_f32 v[12:13], v[68:69], v[68:69]
    v_pk_mul_f32 v[14:15], v[70:71], v[70:71]
    v_pk_fma_f32 v[8:9], v[8:9], s[56:57], v[6:7] op_sel:[0,0,1]
    v_pk_fma_f32 v[10:11], v[10:11], s[56:57], v[6:7] op_sel:[0,0,1]
    v_pk_fma_f32 v[12:13], v[12:13], s[56:57], v[6:7] op_sel:[0,0,1]
    v_pk_fma_f32 v[14:15], v[14:15], s[56:57], v[6:7] op_sel:[0,0,1]
    v_pk_mul_f32 v[8:9], v[8:9], v[64:65]
    v_pk_mul_f32 v[10:11], v[10:11], v[66:67]
    v_pk_mul_f32 v[12:13], v[12:13], v[68:69]
    v_pk_mul_f32 v[14:15], v[14:15], v[70:71]
    v_exp_f32 v8, v8
    v_exp_f32 v9, v9
    v_exp_f32 v10, v10
    v_exp_f32 v11, v11
    v_exp_f32 v12, v12
    v_exp_f32 v13, v13
    v_exp_f32 v14, v14
    v_exp_f32 v15, v15
    v_pk_add_f32 v[8:9], v[8:9], 1.0 op_sel_hi:[1,0]
    v_pk_add_f32 v[10:11], v[10:11], 1.0 op_sel_hi:[1,0]
    v_pk_add_f32 v[12:13], v[12:13], 1.0 op_sel_hi:[1,0]
    v_pk_add_f32 v[14:15], v[14:15], 1.0 op_sel_hi:[1,0]
    v_rcp_f32 v8, v8
    v_rcp_f32 v9, v9
    v_rcp_f32 v10, v10
    v_rcp_f32 v11, v11
    v_rcp_f32 v12, v12
    v_rcp_f32 v13, v13
    v_rcp_f32 v14, v14
    v_rcp_f32 v15, v15
    v_pk_mul_f32 v[8:9], v[8:9], v[64:65]
    v_pk_mul_f32 v[10:11], v[10:11], v[66:67]
    v_pk_mul_f32 v[12:13], v[12:13], v[68:69]
    v_pk_mul_f32 v[14:15], v[14:15], v[70:71]
    v_pk_mul_f32 v[8:9], v[8:9], v[72:73]
    v_pk_mul_f32 v[10:11], v[10:11], v[74:75]
    v_pk_mul_f32 v[12:13], v[12:13], v[76:77]
    v_pk_mul_f32 v[14:15], v[14:15], v[78:79]
    v_cvt_pk_bf16_f32 v36, v8, v9
    v_cvt_pk_bf16_f32 v37, v10, v11
    v_cvt_pk_bf16_f32 v38, v12, v13
    v_cvt_pk_bf16_f32 v39, v14, v15
    v_pk_mul_f32 v[8:9], v[80:81], v[80:81]
    v_pk_mul_f32 v[10:11], v[82:83], v[82:83]
    v_pk_mul_f32 v[12:13], v[84:85], v[84:85]
    v_pk_mul_f32 v[14:15], v[86:87], v[86:87]
    v_pk_fma_f32 v[8:9], v[8:9], s[56:57], v[6:7] op_sel:[0,0,1]
    v_pk_fma_f32 v[10:11], v[10:11], s[56:57], v[6:7] op_sel:[0,0,1]
    v_pk_fma_f32 v[12:13], v[12:13], s[56:57], v[6:7] op_sel:[0,0,1]
    v_pk_fma_f32 v[14:15], v[14:15], s[56:57], v[6:7] op_sel:[0,0,1]
    v_pk_mul_f32 v[8:9], v[8:9], v[80:81]
    v_pk_mul_f32 v[10:11], v[10:11], v[82:83]
    v_pk_mul_f32 v[12:13], v[12:13], v[84:85]
    v_pk_mul_f32 v[14:15], v[14:15], v[86:87]
    v_exp_f32 v8, v8
    v_exp_f32 v9, v9
    v_exp_f32 v10, v10
    v_exp_f32 v11, v11
    v_exp_f32 v12, v12
    v_exp_f32 v13, v13
    v_exp_f32 v14, v14
    v_exp_f32 v15, v15
    v_pk_add_f32 v[8:9], v[8:9], 1.0 op_sel_hi:[1,0]
    v_pk_add_f32 v[10:11], v[10:11], 1.0 op_sel_hi:[1,0]
    v_pk_add_f32 v[12:13], v[12:13], 1.0 op_sel_hi:[1,0]
    v_pk_add_f32 v[14:15], v[14:15], 1.0 op_sel_hi:[1,0]
    v_rcp_f32 v8, v8
    v_rcp_f32 v9, v9
    v_rcp_f32 v10, v10
    v_rcp_f32 v11, v11
    v_rcp_f32 v12, v12
    v_rcp_f32 v13, v13
    v_rcp_f32 v14, v14
    v_rcp_f32 v15, v15
    v_pk_mul_f32 v[8:9], v[8:9], v[80:81]
    v_pk_mul_f32 v[10:11], v[10:11], v[82:83]
    v_pk_mul_f32 v[12:13], v[12:13], v[84:85]
    v_pk_mul_f32 v[14:15], v[14:15], v[86:87]
    v_pk_mul_f32 v[8:9], v[8:9], v[88:89]
    v_pk_mul_f32 v[10:11], v[10:11], v[90:91]
    v_pk_mul_f32 v[12:13], v[12:13], v[92:93]
    v_pk_mul_f32 v[14:15], v[14:15], v[94:95]
    v_cvt_pk_bf16_f32 v40, v8, v9
    v_cvt_pk_bf16_f32 v41, v10, v11
    v_cvt_pk_bf16_f32 v42, v12, v13
    v_cvt_pk_bf16_f32 v43, v14, v15
    s_barrier
    v_add_u32 v2, 0x20000, v2
    ds_read_b64_tr_b16 v[16:17], v2 offset:0
    ds_read_b64_tr_b16 v[18:19], v2 offset:512
    ds_read_b64_tr_b16 v[20:21], v2 offset:8192
    ds_read_b64_tr_b16 v[22:23], v2 offset:8704
    v_add_u32 v3, 0x20000, v3
    ds_read_b64_tr_b16 v[24:25], v3 offset:0
    ds_read_b64_tr_b16 v[26:27], v3 offset:512
    v_pk_mul_f32 v[8:9], v[96:97], v[96:97]
    v_pk_mul_f32 v[10:11], v[98:99], v[98:99]
    v_pk_mul_f32 v[12:13], v[100:101], v[100:101]
    v_pk_mul_f32 v[14:15], v[102:103], v[102:103]
    v_pk_fma_f32 v[8:9], v[8:9], s[56:57], v[6:7] op_sel:[0,0,1]
    v_pk_fma_f32 v[10:11], v[10:11], s[56:57], v[6:7] op_sel:[0,0,1]
    v_pk_fma_f32 v[12:13], v[12:13], s[56:57], v[6:7] op_sel:[0,0,1]
    v_pk_fma_f32 v[14:15], v[14:15], s[56:57], v[6:7] op_sel:[0,0,1]
    v_pk_mul_f32 v[8:9], v[8:9], v[96:97]
    v_pk_mul_f32 v[10:11], v[10:11], v[98:99]
    v_pk_mul_f32 v[12:13], v[12:13], v[100:101]
    v_pk_mul_f32 v[14:15], v[14:15], v[102:103]
    v_exp_f32 v8, v8
    v_exp_f32 v9, v9
    v_exp_f32 v10, v10
    v_exp_f32 v11, v11
    v_exp_f32 v12, v12
    v_exp_f32 v13, v13
    v_exp_f32 v14, v14
    v_exp_f32 v15, v15
    v_pk_add_f32 v[8:9], v[8:9], 1.0 op_sel_hi:[1,0]
    v_pk_add_f32 v[10:11], v[10:11], 1.0 op_sel_hi:[1,0]
    v_pk_add_f32 v[12:13], v[12:13], 1.0 op_sel_hi:[1,0]
    v_pk_add_f32 v[14:15], v[14:15], 1.0 op_sel_hi:[1,0]
    v_rcp_f32 v8, v8
    v_rcp_f32 v9, v9
    v_rcp_f32 v10, v10
    v_rcp_f32 v11, v11
    v_rcp_f32 v12, v12
    v_rcp_f32 v13, v13
    v_rcp_f32 v14, v14
    v_rcp_f32 v15, v15
    v_pk_mul_f32 v[8:9], v[8:9], v[96:97]
    v_pk_mul_f32 v[10:11], v[10:11], v[98:99]
    v_pk_mul_f32 v[12:13], v[12:13], v[100:101]
    v_pk_mul_f32 v[14:15], v[14:15], v[102:103]
    v_pk_mul_f32 v[8:9], v[8:9], v[104:105]
    v_pk_mul_f32 v[10:11], v[10:11], v[106:107]
    v_pk_mul_f32 v[12:13], v[12:13], v[108:109]
    v_pk_mul_f32 v[14:15], v[14:15], v[110:111]
    v_cvt_pk_bf16_f32 v44, v8, v9
    v_cvt_pk_bf16_f32 v45, v10, v11
    v_cvt_pk_bf16_f32 v46, v12, v13
    v_cvt_pk_bf16_f32 v47, v14, v15
    s_setprio 0
    ds_read_b64_tr_b16 v[28:29], v3 offset:8192
    s_waitcnt lgkmcnt(3)
    v_mfma_f32_16x16x32_bf16 v[48:51], v[16:19], a[0:3], 0
    ds_read_b64_tr_b16 v[30:31], v3 offset:8704
    v_add_u32 v4, 0x20000, v4
    v_mfma_f32_16x16x32_bf16 v[64:67], v[16:19], a[4:7], 0
    ds_read_b64_tr_b16 v[16:17], v4 offset:0
    v_mfma_f32_16x16x32_bf16 v[56:59], v[20:23], a[0:3], 0
    ds_read_b64_tr_b16 v[18:19], v4 offset:512
    v_mfma_f32_16x16x32_bf16 v[72:75], v[20:23], a[4:7], 0
    ds_read_b64_tr_b16 v[20:21], v4 offset:8192
    s_waitcnt lgkmcnt(3)
    v_mfma_f32_16x16x32_bf16 v[52:55], v[24:27], a[0:3], 0
    ds_read_b64_tr_b16 v[22:23], v4 offset:8704
    v_add_u32 v5, 0x20000, v5
    v_mfma_f32_16x16x32_bf16 v[68:71], v[24:27], a[4:7], 0
    ds_read_b64_tr_b16 v[24:25], v5 offset:0
    v_mfma_f32_16x16x32_bf16 v[60:63], v[28:31], a[0:3], 0
    ds_read_b64_tr_b16 v[26:27], v5 offset:512
    v_mfma_f32_16x16x32_bf16 v[76:79], v[28:31], a[4:7], 0
    ds_read_b64_tr_b16 v[28:29], v5 offset:8192
    s_waitcnt lgkmcnt(3)
    v_mfma_f32_16x16x32_bf16 v[80:83], v[16:19], a[0:3], 0
    ds_read_b64_tr_b16 v[30:31], v5 offset:8704
    buffer_store_dwordx4 v[32:35], v1, s[24:27], s8 offen sc1
    v_mfma_f32_16x16x32_bf16 v[96:99], v[16:19], a[4:7], 0
    ds_read_b64_tr_b16 v[16:17], v2 offset:4096
    v_mfma_f32_16x16x32_bf16 v[88:91], v[20:23], a[0:3], 0
    ds_read_b64_tr_b16 v[18:19], v2 offset:4608
    v_mfma_f32_16x16x32_bf16 v[104:107], v[20:23], a[4:7], 0
    ds_read_b64_tr_b16 v[20:21], v2 offset:12288
    s_waitcnt lgkmcnt(3)
    v_mfma_f32_16x16x32_bf16 v[84:87], v[24:27], a[0:3], 0
    ds_read_b64_tr_b16 v[22:23], v2 offset:12800
    v_mfma_f32_16x16x32_bf16 v[100:103], v[24:27], a[4:7], 0
    ds_read_b64_tr_b16 v[24:25], v3 offset:4096
    v_mfma_f32_16x16x32_bf16 v[92:95], v[28:31], a[0:3], 0
    ds_read_b64_tr_b16 v[26:27], v3 offset:4608
    v_mfma_f32_16x16x32_bf16 v[108:111], v[28:31], a[4:7], 0
    ds_read_b64_tr_b16 v[28:29], v3 offset:12288
    s_waitcnt lgkmcnt(3)
    v_mfma_f32_16x16x32_bf16 v[48:51], v[16:19], a[8:11], v[48:51]
    ds_read_b64_tr_b16 v[30:31], v3 offset:12800
    v_mfma_f32_16x16x32_bf16 v[64:67], v[16:19], a[12:15], v[64:67]
    ds_read_b64_tr_b16 v[16:17], v4 offset:4096
    v_mfma_f32_16x16x32_bf16 v[56:59], v[20:23], a[8:11], v[56:59]
    ds_read_b64_tr_b16 v[18:19], v4 offset:4608
    v_mfma_f32_16x16x32_bf16 v[72:75], v[20:23], a[12:15], v[72:75]
    ds_read_b64_tr_b16 v[20:21], v4 offset:12288
    s_waitcnt lgkmcnt(3)
    v_mfma_f32_16x16x32_bf16 v[52:55], v[24:27], a[8:11], v[52:55]
    ds_read_b64_tr_b16 v[22:23], v4 offset:12800
    v_mfma_f32_16x16x32_bf16 v[68:71], v[24:27], a[12:15], v[68:71]
    ds_read_b64_tr_b16 v[24:25], v5 offset:4096
    v_mfma_f32_16x16x32_bf16 v[60:63], v[28:31], a[8:11], v[60:63]
    ds_read_b64_tr_b16 v[26:27], v5 offset:4608
    v_mfma_f32_16x16x32_bf16 v[76:79], v[28:31], a[12:15], v[76:79]
    ds_read_b64_tr_b16 v[28:29], v5 offset:12288
    s_waitcnt lgkmcnt(3)
    v_mfma_f32_16x16x32_bf16 v[80:83], v[16:19], a[8:11], v[80:83]
    ds_read_b64_tr_b16 v[30:31], v5 offset:12800
    buffer_store_dwordx4 v[36:39], v1, s[24:27], s9 offen sc1
    v_mfma_f32_16x16x32_bf16 v[96:99], v[16:19], a[12:15], v[96:99]
    s_barrier
    ds_read_b64_tr_b16 v[16:17], v2 offset:16384
    v_mfma_f32_16x16x32_bf16 v[88:91], v[20:23], a[8:11], v[88:91]
    ds_read_b64_tr_b16 v[18:19], v2 offset:16896
    v_mfma_f32_16x16x32_bf16 v[104:107], v[20:23], a[12:15], v[104:107]
    ds_read_b64_tr_b16 v[20:21], v2 offset:24576
    s_waitcnt lgkmcnt(3)
    v_mfma_f32_16x16x32_bf16 v[84:87], v[24:27], a[8:11], v[84:87]
    ds_read_b64_tr_b16 v[22:23], v2 offset:25088
    v_mfma_f32_16x16x32_bf16 v[100:103], v[24:27], a[12:15], v[100:103]
    ds_read_b64_tr_b16 v[24:25], v3 offset:16384
    v_mfma_f32_16x16x32_bf16 v[92:95], v[28:31], a[8:11], v[92:95]
    ds_read_b64_tr_b16 v[26:27], v3 offset:16896
    v_mfma_f32_16x16x32_bf16 v[108:111], v[28:31], a[12:15], v[108:111]
    ds_read_b64_tr_b16 v[28:29], v3 offset:24576
    s_waitcnt lgkmcnt(3)
    v_mfma_f32_16x16x32_bf16 v[48:51], v[16:19], a[16:19], v[48:51]
    ds_read_b64_tr_b16 v[30:31], v3 offset:25088
    v_mfma_f32_16x16x32_bf16 v[64:67], v[16:19], a[20:23], v[64:67]
    ds_read_b64_tr_b16 v[16:17], v4 offset:16384
    v_mfma_f32_16x16x32_bf16 v[56:59], v[20:23], a[16:19], v[56:59]
    ds_read_b64_tr_b16 v[18:19], v4 offset:16896
    v_mfma_f32_16x16x32_bf16 v[72:75], v[20:23], a[20:23], v[72:75]
    ds_read_b64_tr_b16 v[20:21], v4 offset:24576
    s_waitcnt lgkmcnt(3)
    v_mfma_f32_16x16x32_bf16 v[52:55], v[24:27], a[16:19], v[52:55]
    ds_read_b64_tr_b16 v[22:23], v4 offset:25088
    v_mfma_f32_16x16x32_bf16 v[68:71], v[24:27], a[20:23], v[68:71]
    ds_read_b64_tr_b16 v[24:25], v5 offset:16384
    v_mfma_f32_16x16x32_bf16 v[60:63], v[28:31], a[16:19], v[60:63]
    ds_read_b64_tr_b16 v[26:27], v5 offset:16896
    v_mfma_f32_16x16x32_bf16 v[76:79], v[28:31], a[20:23], v[76:79]
    ds_read_b64_tr_b16 v[28:29], v5 offset:24576
    s_waitcnt lgkmcnt(3)
    v_mfma_f32_16x16x32_bf16 v[80:83], v[16:19], a[16:19], v[80:83]
    ds_read_b64_tr_b16 v[30:31], v5 offset:25088
    buffer_store_dwordx4 v[40:43], v1, s[24:27], s10 offen sc1
    v_mfma_f32_16x16x32_bf16 v[96:99], v[16:19], a[20:23], v[96:99]
    ds_read_b64_tr_b16 v[16:17], v2 offset:20480
    v_mfma_f32_16x16x32_bf16 v[88:91], v[20:23], a[16:19], v[88:91]
    ds_read_b64_tr_b16 v[18:19], v2 offset:20992
    v_mfma_f32_16x16x32_bf16 v[104:107], v[20:23], a[20:23], v[104:107]
    ds_read_b64_tr_b16 v[20:21], v2 offset:28672
    s_waitcnt lgkmcnt(3)
    v_mfma_f32_16x16x32_bf16 v[84:87], v[24:27], a[16:19], v[84:87]
    ds_read_b64_tr_b16 v[22:23], v2 offset:29184
    v_mfma_f32_16x16x32_bf16 v[100:103], v[24:27], a[20:23], v[100:103]
    ds_read_b64_tr_b16 v[24:25], v3 offset:20480
    v_mfma_f32_16x16x32_bf16 v[92:95], v[28:31], a[16:19], v[92:95]
    ds_read_b64_tr_b16 v[26:27], v3 offset:20992
    v_mfma_f32_16x16x32_bf16 v[108:111], v[28:31], a[20:23], v[108:111]
    ds_read_b64_tr_b16 v[28:29], v3 offset:28672
    s_waitcnt lgkmcnt(3)
    v_mfma_f32_16x16x32_bf16 v[48:51], v[16:19], a[24:27], v[48:51]
    ds_read_b64_tr_b16 v[30:31], v3 offset:29184
    v_mfma_f32_16x16x32_bf16 v[64:67], v[16:19], a[28:31], v[64:67]
    ds_read_b64_tr_b16 v[16:17], v4 offset:20480
    v_mfma_f32_16x16x32_bf16 v[56:59], v[20:23], a[24:27], v[56:59]
    ds_read_b64_tr_b16 v[18:19], v4 offset:20992
    v_mfma_f32_16x16x32_bf16 v[72:75], v[20:23], a[28:31], v[72:75]
    ds_read_b64_tr_b16 v[20:21], v4 offset:28672
    s_waitcnt lgkmcnt(3)
    v_mfma_f32_16x16x32_bf16 v[52:55], v[24:27], a[24:27], v[52:55]
    ds_read_b64_tr_b16 v[22:23], v4 offset:29184
    v_mfma_f32_16x16x32_bf16 v[68:71], v[24:27], a[28:31], v[68:71]
    ds_read_b64_tr_b16 v[24:25], v5 offset:20480
    v_mfma_f32_16x16x32_bf16 v[60:63], v[28:31], a[24:27], v[60:63]
    ds_read_b64_tr_b16 v[26:27], v5 offset:20992
    v_add_u32 v2, 0xfffe0000, v2
    v_mfma_f32_16x16x32_bf16 v[76:79], v[28:31], a[28:31], v[76:79]
    ds_read_b64_tr_b16 v[28:29], v5 offset:28672
    s_waitcnt lgkmcnt(3)
    v_mfma_f32_16x16x32_bf16 v[80:83], v[16:19], a[24:27], v[80:83]
    ds_read_b64_tr_b16 v[30:31], v5 offset:29184
    buffer_store_dwordx4 v[44:47], v1, s[24:27], s11 offen sc1
    v_mfma_f32_16x16x32_bf16 v[96:99], v[16:19], a[28:31], v[96:99]
    s_barrier
    ds_read_b64_tr_b16 v[16:17], v2 offset:16384
    v_mfma_f32_16x16x32_bf16 v[88:91], v[20:23], a[24:27], v[88:91]
    ds_read_b64_tr_b16 v[18:19], v2 offset:16896
    v_mfma_f32_16x16x32_bf16 v[104:107], v[20:23], a[28:31], v[104:107]
    ds_read_b64_tr_b16 v[20:21], v2 offset:24576
    s_waitcnt lgkmcnt(3)
    v_mfma_f32_16x16x32_bf16 v[84:87], v[24:27], a[24:27], v[84:87]
    ds_read_b64_tr_b16 v[22:23], v2 offset:25088
    v_add_u32 v3, 0xfffe0000, v3
    v_mfma_f32_16x16x32_bf16 v[100:103], v[24:27], a[28:31], v[100:103]
    ds_read_b64_tr_b16 v[24:25], v3 offset:16384
    v_mfma_f32_16x16x32_bf16 v[92:95], v[28:31], a[24:27], v[92:95]
    ds_read_b64_tr_b16 v[26:27], v3 offset:16896
    v_mfma_f32_16x16x32_bf16 v[108:111], v[28:31], a[28:31], v[108:111]
    ds_read_b64_tr_b16 v[28:29], v3 offset:24576
    s_waitcnt lgkmcnt(3)
    v_mfma_f32_16x16x32_bf16 v[48:51], v[16:19], a[32:35], v[48:51]
    ds_read_b64_tr_b16 v[30:31], v3 offset:25088
    v_add_u32 v4, 0xfffe0000, v4
    v_mfma_f32_16x16x32_bf16 v[64:67], v[16:19], a[36:39], v[64:67]
    ds_read_b64_tr_b16 v[16:17], v4 offset:16384
    v_mfma_f32_16x16x32_bf16 v[56:59], v[20:23], a[32:35], v[56:59]
    ds_read_b64_tr_b16 v[18:19], v4 offset:16896
    v_mfma_f32_16x16x32_bf16 v[72:75], v[20:23], a[36:39], v[72:75]
    ds_read_b64_tr_b16 v[20:21], v4 offset:24576
    s_waitcnt lgkmcnt(3)
    v_mfma_f32_16x16x32_bf16 v[52:55], v[24:27], a[32:35], v[52:55]
    ds_read_b64_tr_b16 v[22:23], v4 offset:25088
    s_branch L_skippad2
.p2align 12
L_pad2:
    s_setpc_b64 s[50:51]
L_skippad2:
    v_add_u32 v5, 0xfffe0000, v5
    v_mfma_f32_16x16x32_bf16 v[68:71], v[24:27], a[36:39], v[68:71]
    ds_read_b64_tr_b16 v[24:25], v5 offset:16384
    v_mfma_f32_16x16x32_bf16 v[60:63], v[28:31], a[32:35], v[60:63]
    ds_read_b64_tr_b16 v[26:27], v5 offset:16896
    v_mfma_f32_16x16x32_bf16 v[76:79], v[28:31], a[36:39], v[76:79]
    ds_read_b64_tr_b16 v[28:29], v5 offset:24576
    s_waitcnt lgkmcnt(3)
    v_mfma_f32_16x16x32_bf16 v[80:83], v[16:19], a[32:35], v[80:83]
    ds_read_b64_tr_b16 v[30:31], v5 offset:25088
    v_mfma_f32_16x16x32_bf16 v[96:99], v[16:19], a[36:39], v[96:99]
    ds_read_b64_tr_b16 v[16:17], v2 offset:20480
    v_mfma_f32_16x16x32_bf16 v[88:91], v[20:23], a[32:35], v[88:91]
    ds_read_b64_tr_b16 v[18:19], v2 offset:20992
    v_mfma_f32_16x16x32_bf16 v[104:107], v[20:23], a[36:39], v[104:107]
    ds_read_b64_tr_b16 v[20:21], v2 offset:28672
    s_waitcnt lgkmcnt(3)
    v_mfma_f32_16x16x32_bf16 v[84:87], v[24:27], a[32:35], v[84:87]
    ds_read_b64_tr_b16 v[22:23], v2 offset:29184
    v_mfma_f32_16x16x32_bf16 v[100:103], v[24:27], a[36:39], v[100:103]
    ds_read_b64_tr_b16 v[24:25], v3 offset:20480
    v_mfma_f32_16x16x32_bf16 v[92:95], v[28:31], a[32:35], v[92:95]
    ds_read_b64_tr_b16 v[26:27], v3 offset:20992
    v_mfma_f32_16x16x32_bf16 v[108:111], v[28:31], a[36:39], v[108:111]
    ds_read_b64_tr_b16 v[28:29], v3 offset:28672
    s_waitcnt lgkmcnt(3)
    v_mfma_f32_16x16x32_bf16 v[48:51], v[16:19], a[40:43], v[48:51]
    ds_read_b64_tr_b16 v[30:31], v3 offset:29184
    v_mfma_f32_16x16x32_bf16 v[64:67], v[16:19], a[44:47], v[64:67]
    ds_read_b64_tr_b16 v[16:17], v4 offset:20480
    v_mfma_f32_16x16x32_bf16 v[56:59], v[20:23], a[40:43], v[56:59]
    ds_read_b64_tr_b16 v[18:19], v4 offset:20992
    v_mfma_f32_16x16x32_bf16 v[72:75], v[20:23], a[44:47], v[72:75]
    ds_read_b64_tr_b16 v[20:21], v4 offset:28672
    s_waitcnt lgkmcnt(3)
    v_mfma_f32_16x16x32_bf16 v[52:55], v[24:27], a[40:43], v[52:55]
    ds_read_b64_tr_b16 v[22:23], v4 offset:29184
    v_mfma_f32_16x16x32_bf16 v[68:71], v[24:27], a[44:47], v[68:71]
    ds_read_b64_tr_b16 v[24:25], v5 offset:20480
    v_mfma_f32_16x16x32_bf16 v[60:63], v[28:31], a[40:43], v[60:63]
    ds_read_b64_tr_b16 v[26:27], v5 offset:20992
    v_mfma_f32_16x16x32_bf16 v[76:79], v[28:31], a[44:47], v[76:79]
    ds_read_b64_tr_b16 v[28:29], v5 offset:28672
    s_waitcnt lgkmcnt(3)
    v_mfma_f32_16x16x32_bf16 v[80:83], v[16:19], a[40:43], v[80:83]
    ds_read_b64_tr_b16 v[30:31], v5 offset:29184
    v_add_u32 v2, 0x10000, v2
    v_mfma_f32_16x16x32_bf16 v[96:99], v[16:19], a[44:47], v[96:99]
    s_barrier
    ds_read_b64_tr_b16 v[16:17], v2 offset:16384
    v_mfma_f32_16x16x32_bf16 v[88:91], v[20:23], a[40:43], v[88:91]
    ds_read_b64_tr_b16 v[18:19], v2 offset:16896
    v_mfma_f32_16x16x32_bf16 v[104:107], v[20:23], a[44:47], v[104:107]
    ds_read_b64_tr_b16 v[20:21], v2 offset:24576
    s_waitcnt lgkmcnt(3)
    v_mfma_f32_16x16x32_bf16 v[84:87], v[24:27], a[40:43], v[84:87]
    ds_read_b64_tr_b16 v[22:23], v2 offset:25088
    v_add_u32 v3, 0x10000, v3
    v_mfma_f32_16x16x32_bf16 v[100:103], v[24:27], a[44:47], v[100:103]
    ds_read_b64_tr_b16 v[24:25], v3 offset:16384
    v_mfma_f32_16x16x32_bf16 v[92:95], v[28:31], a[40:43], v[92:95]
    ds_read_b64_tr_b16 v[26:27], v3 offset:16896
    v_mfma_f32_16x16x32_bf16 v[108:111], v[28:31], a[44:47], v[108:111]
    ds_read_b64_tr_b16 v[28:29], v3 offset:24576
    s_waitcnt lgkmcnt(3)
    v_mfma_f32_16x16x32_bf16 v[48:51], v[16:19], a[48:51], v[48:51]
    ds_read_b64_tr_b16 v[30:31], v3 offset:25088
    v_add_u32 v4, 0x10000, v4
    v_mfma_f32_16x16x32_bf16 v[64:67], v[16:19], a[52:55], v[64:67]
    ds_read_b64_tr_b16 v[16:17], v4 offset:16384
    v_mfma_f32_16x16x32_bf16 v[56:59], v[20:23], a[48:51], v[56:59]
    ds_read_b64_tr_b16 v[18:19], v4 offset:16896
    v_mfma_f32_16x16x32_bf16 v[72:75], v[20:23], a[52:55], v[72:75]
    ds_read_b64_tr_b16 v[20:21], v4 offset:24576
    s_waitcnt lgkmcnt(3)
    v_mfma_f32_16x16x32_bf16 v[52:55], v[24:27], a[48:51], v[52:55]
    ds_read_b64_tr_b16 v[22:23], v4 offset:25088
    v_add_u32 v5, 0x10000, v5
    v_mfma_f32_16x16x32_bf16 v[68:71], v[24:27], a[52:55], v[68:71]
    ds_read_b64_tr_b16 v[24:25], v5 offset:16384
    v_mfma_f32_16x16x32_bf16 v[60:63], v[28:31], a[48:51], v[60:63]
    ds_read_b64_tr_b16 v[26:27], v5 offset:16896
    v_mfma_f32_16x16x32_bf16 v[76:79], v[28:31], a[52:55], v[76:79]
    ds_read_b64_tr_b16 v[28:29], v5 offset:24576
    s_waitcnt lgkmcnt(3)
    v_mfma_f32_16x16x32_bf16 v[80:83], v[16:19], a[48:51], v[80:83]
    ds_read_b64_tr_b16 v[30:31], v5 offset:25088
    v_mfma_f32_16x16x32_bf16 v[96:99], v[16:19], a[52:55], v[96:99]
    ds_read_b64_tr_b16 v[16:17], v2 offset:20480
    v_mfma_f32_16x16x32_bf16 v[88:91], v[20:23], a[48:51], v[88:91]
    ds_read_b64_tr_b16 v[18:19], v2 offset:20992
    v_mfma_f32_16x16x32_bf16 v[104:107], v[20:23], a[52:55], v[104:107]
    ds_read_b64_tr_b16 v[20:21], v2 offset:28672
    s_waitcnt lgkmcnt(3)
    v_mfma_f32_16x16x32_bf16 v[84:87], v[24:27], a[48:51], v[84:87]
    ds_read_b64_tr_b16 v[22:23], v2 offset:29184
    v_mfma_f32_16x16x32_bf16 v[100:103], v[24:27], a[52:55], v[100:103]
    ds_read_b64_tr_b16 v[24:25], v3 offset:20480
    v_mfma_f32_16x16x32_bf16 v[92:95], v[28:31], a[48:51], v[92:95]
    ds_read_b64_tr_b16 v[26:27], v3 offset:20992
    v_mfma_f32_16x16x32_bf16 v[108:111], v[28:31], a[52:55], v[108:111]
    ds_read_b64_tr_b16 v[28:29], v3 offset:28672
    s_waitcnt lgkmcnt(3)
    v_mfma_f32_16x16x32_bf16 v[48:51], v[16:19], a[56:59], v[48:51]
    ds_read_b64_tr_b16 v[30:31], v3 offset:29184
    v_mfma_f32_16x16x32_bf16 v[64:67], v[16:19], a[60:63], v[64:67]
    ds_read_b64_tr_b16 v[16:17], v4 offset:20480
    v_mfma_f32_16x16x32_bf16 v[56:59], v[20:23], a[56:59], v[56:59]
    ds_read_b64_tr_b16 v[18:19], v4 offset:20992
    v_mfma_f32_16x16x32_bf16 v[72:75], v[20:23], a[60:63], v[72:75]
    ds_read_b64_tr_b16 v[20:21], v4 offset:28672
    s_waitcnt lgkmcnt(3)
    v_mfma_f32_16x16x32_bf16 v[52:55], v[24:27], a[56:59], v[52:55]
    ds_read_b64_tr_b16 v[22:23], v4 offset:29184
    v_mfma_f32_16x16x32_bf16 v[68:71], v[24:27], a[60:63], v[68:71]
    ds_read_b64_tr_b16 v[24:25], v5 offset:20480
    v_mfma_f32_16x16x32_bf16 v[60:63], v[28:31], a[56:59], v[60:63]
    ds_read_b64_tr_b16 v[26:27], v5 offset:20992
    v_mfma_f32_16x16x32_bf16 v[76:79], v[28:31], a[60:63], v[76:79]
    ds_read_b64_tr_b16 v[28:29], v5 offset:28672
    s_waitcnt lgkmcnt(3)
    v_mfma_f32_16x16x32_bf16 v[80:83], v[16:19], a[56:59], v[80:83]
    ds_read_b64_tr_b16 v[30:31], v5 offset:29184
    v_add_u32 v2, 0xffff0000, v2
    v_mfma_f32_16x16x32_bf16 v[96:99], v[16:19], a[60:63], v[96:99]
    s_barrier
    ds_read_b64_tr_b16 v[16:17], v2 offset:32768
    v_mfma_f32_16x16x32_bf16 v[88:91], v[20:23], a[56:59], v[88:91]
    ds_read_b64_tr_b16 v[18:19], v2 offset:33280
    v_mfma_f32_16x16x32_bf16 v[104:107], v[20:23], a[60:63], v[104:107]
    ds_read_b64_tr_b16 v[20:21], v2 offset:40960
    s_waitcnt lgkmcnt(3)
    v_mfma_f32_16x16x32_bf16 v[84:87], v[24:27], a[56:59], v[84:87]
    ds_read_b64_tr_b16 v[22:23], v2 offset:41472
    v_add_u32 v3, 0xffff0000, v3
    v_mfma_f32_16x16x32_bf16 v[100:103], v[24:27], a[60:63], v[100:103]
    ds_read_b64_tr_b16 v[24:25], v3 offset:32768
    v_mfma_f32_16x16x32_bf16 v[92:95], v[28:31], a[56:59], v[92:95]
    ds_read_b64_tr_b16 v[26:27], v3 offset:33280
    v_mfma_f32_16x16x32_bf16 v[108:111], v[28:31], a[60:63], v[108:111]
    ds_read_b64_tr_b16 v[28:29], v3 offset:40960
    s_waitcnt lgkmcnt(3)
    v_mfma_f32_16x16x32_bf16 v[48:51], v[16:19], a[64:67], v[48:51]
    ds_read_b64_tr_b16 v[30:31], v3 offset:41472
    v_add_u32 v4, 0xffff0000, v4
    v_mfma_f32_16x16x32_bf16 v[64:67], v[16:19], a[68:71], v[64:67]
    ds_read_b64_tr_b16 v[16:17], v4 offset:32768
    v_mfma_f32_16x16x32_bf16 v[56:59], v[20:23], a[64:67], v[56:59]
    ds_read_b64_tr_b16 v[18:19], v4 offset:33280
    v_mfma_f32_16x16x32_bf16 v[72:75], v[20:23], a[68:71], v[72:75]
    ds_read_b64_tr_b16 v[20:21], v4 offset:40960
    s_waitcnt lgkmcnt(3)
    v_mfma_f32_16x16x32_bf16 v[52:55], v[24:27], a[64:67], v[52:55]
    ds_read_b64_tr_b16 v[22:23], v4 offset:41472
    v_add_u32 v5, 0xffff0000, v5
    v_mfma_f32_16x16x32_bf16 v[68:71], v[24:27], a[68:71], v[68:71]
    ds_read_b64_tr_b16 v[24:25], v5 offset:32768
    v_mfma_f32_16x16x32_bf16 v[60:63], v[28:31], a[64:67], v[60:63]
    ds_read_b64_tr_b16 v[26:27], v5 offset:33280
    v_mfma_f32_16x16x32_bf16 v[76:79], v[28:31], a[68:71], v[76:79]
    ds_read_b64_tr_b16 v[28:29], v5 offset:40960
    s_waitcnt lgkmcnt(3)
    v_mfma_f32_16x16x32_bf16 v[80:83], v[16:19], a[64:67], v[80:83]
    ds_read_b64_tr_b16 v[30:31], v5 offset:41472
    v_mfma_f32_16x16x32_bf16 v[96:99], v[16:19], a[68:71], v[96:99]
    ds_read_b64_tr_b16 v[16:17], v2 offset:36864
    v_mfma_f32_16x16x32_bf16 v[88:91], v[20:23], a[64:67], v[88:91]
    ds_read_b64_tr_b16 v[18:19], v2 offset:37376
    v_mfma_f32_16x16x32_bf16 v[104:107], v[20:23], a[68:71], v[104:107]
    ds_read_b64_tr_b16 v[20:21], v2 offset:45056
    s_waitcnt lgkmcnt(3)
    v_mfma_f32_16x16x32_bf16 v[84:87], v[24:27], a[64:67], v[84:87]
    ds_read_b64_tr_b16 v[22:23], v2 offset:45568
    v_mfma_f32_16x16x32_bf16 v[100:103], v[24:27], a[68:71], v[100:103]
    ds_read_b64_tr_b16 v[24:25], v3 offset:36864
    v_mfma_f32_16x16x32_bf16 v[92:95], v[28:31], a[64:67], v[92:95]
    ds_read_b64_tr_b16 v[26:27], v3 offset:37376
    v_mfma_f32_16x16x32_bf16 v[108:111], v[28:31], a[68:71], v[108:111]
    ds_read_b64_tr_b16 v[28:29], v3 offset:45056
    s_waitcnt lgkmcnt(3)
    v_mfma_f32_16x16x32_bf16 v[48:51], v[16:19], a[72:75], v[48:51]
    ds_read_b64_tr_b16 v[30:31], v3 offset:45568
    v_mfma_f32_16x16x32_bf16 v[64:67], v[16:19], a[76:79], v[64:67]
    ds_read_b64_tr_b16 v[16:17], v4 offset:36864
    v_mfma_f32_16x16x32_bf16 v[56:59], v[20:23], a[72:75], v[56:59]
    ds_read_b64_tr_b16 v[18:19], v4 offset:37376
    v_mfma_f32_16x16x32_bf16 v[72:75], v[20:23], a[76:79], v[72:75]
    ds_read_b64_tr_b16 v[20:21], v4 offset:45056
    s_waitcnt lgkmcnt(3)
    v_mfma_f32_16x16x32_bf16 v[52:55], v[24:27], a[72:75], v[52:55]
    ds_read_b64_tr_b16 v[22:23], v4 offset:45568
    v_mfma_f32_16x16x32_bf16 v[68:71], v[24:27], a[76:79], v[68:71]
    ds_read_b64_tr_b16 v[24:25], v5 offset:36864
    v_mfma_f32_16x16x32_bf16 v[60:63], v[28:31], a[72:75], v[60:63]
    ds_read_b64_tr_b16 v[26:27], v5 offset:37376
    v_mfma_f32_16x16x32_bf16 v[76:79], v[28:31], a[76:79], v[76:79]
    ds_read_b64_tr_b16 v[28:29], v5 offset:45056
    s_waitcnt lgkmcnt(3)
    v_mfma_f32_16x16x32_bf16 v[80:83], v[16:19], a[72:75], v[80:83]
    ds_read_b64_tr_b16 v[30:31], v5 offset:45568
    v_add_u32 v2, 0x10000, v2
    v_mfma_f32_16x16x32_bf16 v[96:99], v[16:19], a[76:79], v[96:99]
    s_waitcnt vmcnt(0)
    s_barrier
    ds_read_b64_tr_b16 v[16:17], v2 offset:32768
    v_mfma_f32_16x16x32_bf16 v[88:91], v[20:23], a[72:75], v[88:91]
    ds_read_b64_tr_b16 v[18:19], v2 offset:33280
    v_mfma_f32_16x16x32_bf16 v[104:107], v[20:23], a[76:79], v[104:107]
    ds_read_b64_tr_b16 v[20:21], v2 offset:40960
    s_waitcnt lgkmcnt(3)
    v_mfma_f32_16x16x32_bf16 v[84:87], v[24:27], a[72:75], v[84:87]
    ds_read_b64_tr_b16 v[22:23], v2 offset:41472
    v_add_u32 v3, 0x10000, v3
    v_mfma_f32_16x16x32_bf16 v[100:103], v[24:27], a[76:79], v[100:103]
    ds_read_b64_tr_b16 v[24:25], v3 offset:32768
    v_mfma_f32_16x16x32_bf16 v[92:95], v[28:31], a[72:75], v[92:95]
    ds_read_b64_tr_b16 v[26:27], v3 offset:33280
    v_mfma_f32_16x16x32_bf16 v[108:111], v[28:31], a[76:79], v[108:111]
    ds_read_b64_tr_b16 v[28:29], v3 offset:40960
    s_waitcnt lgkmcnt(3)
    v_mfma_f32_16x16x32_bf16 v[48:51], v[16:19], a[80:83], v[48:51]
    ds_read_b64_tr_b16 v[30:31], v3 offset:41472
    v_add_u32 v4, 0x10000, v4
    v_mfma_f32_16x16x32_bf16 v[64:67], v[16:19], a[84:87], v[64:67]
    ds_read_b64_tr_b16 v[16:17], v4 offset:32768
    v_mfma_f32_16x16x32_bf16 v[56:59], v[20:23], a[80:83], v[56:59]
    ds_read_b64_tr_b16 v[18:19], v4 offset:33280
    v_mfma_f32_16x16x32_bf16 v[72:75], v[20:23], a[84:87], v[72:75]
    ds_read_b64_tr_b16 v[20:21], v4 offset:40960
    s_waitcnt lgkmcnt(3)
    v_mfma_f32_16x16x32_bf16 v[52:55], v[24:27], a[80:83], v[52:55]
    ds_read_b64_tr_b16 v[22:23], v4 offset:41472
    v_add_u32 v5, 0x10000, v5
    v_mfma_f32_16x16x32_bf16 v[68:71], v[24:27], a[84:87], v[68:71]
    ds_read_b64_tr_b16 v[24:25], v5 offset:32768
    v_mfma_f32_16x16x32_bf16 v[60:63], v[28:31], a[80:83], v[60:63]
    ds_read_b64_tr_b16 v[26:27], v5 offset:33280
    v_mfma_f32_16x16x32_bf16 v[76:79], v[28:31], a[84:87], v[76:79]
    ds_read_b64_tr_b16 v[28:29], v5 offset:40960
    s_waitcnt lgkmcnt(3)
    v_mfma_f32_16x16x32_bf16 v[80:83], v[16:19], a[80:83], v[80:83]
    ds_read_b64_tr_b16 v[30:31], v5 offset:41472
    v_mfma_f32_16x16x32_bf16 v[96:99], v[16:19], a[84:87], v[96:99]
    ds_read_b64_tr_b16 v[16:17], v2 offset:36864
    v_mfma_f32_16x16x32_bf16 v[88:91], v[20:23], a[80:83], v[88:91]
    ds_read_b64_tr_b16 v[18:19], v2 offset:37376
    v_mfma_f32_16x16x32_bf16 v[104:107], v[20:23], a[84:87], v[104:107]
    ds_read_b64_tr_b16 v[20:21], v2 offset:45056
    s_waitcnt lgkmcnt(3)
    v_mfma_f32_16x16x32_bf16 v[84:87], v[24:27], a[80:83], v[84:87]
    ds_read_b64_tr_b16 v[22:23], v2 offset:45568
    v_mfma_f32_16x16x32_bf16 v[100:103], v[24:27], a[84:87], v[100:103]
    ds_read_b64_tr_b16 v[24:25], v3 offset:36864
    v_mfma_f32_16x16x32_bf16 v[92:95], v[28:31], a[80:83], v[92:95]
    ds_read_b64_tr_b16 v[26:27], v3 offset:37376
    v_mfma_f32_16x16x32_bf16 v[108:111], v[28:31], a[84:87], v[108:111]
    ds_read_b64_tr_b16 v[28:29], v3 offset:45056
    s_waitcnt lgkmcnt(3)
    v_mfma_f32_16x16x32_bf16 v[48:51], v[16:19], a[88:91], v[48:51]
    ds_read_b64_tr_b16 v[30:31], v3 offset:45568
    v_mfma_f32_16x16x32_bf16 v[64:67], v[16:19], a[92:95], v[64:67]
    ds_read_b64_tr_b16 v[16:17], v4 offset:36864
    v_mfma_f32_16x16x32_bf16 v[56:59], v[20:23], a[88:91], v[56:59]
    ds_read_b64_tr_b16 v[18:19], v4 offset:37376
    v_mfma_f32_16x16x32_bf16 v[72:75], v[20:23], a[92:95], v[72:75]
    ds_read_b64_tr_b16 v[20:21], v4 offset:45056
    s_waitcnt lgkmcnt(3)
    v_mfma_f32_16x16x32_bf16 v[52:55], v[24:27], a[88:91], v[52:55]
    ds_read_b64_tr_b16 v[22:23], v4 offset:45568
    v_mfma_f32_16x16x32_bf16 v[68:71], v[24:27], a[92:95], v[68:71]
    ds_read_b64_tr_b16 v[24:25], v5 offset:36864
    v_mfma_f32_16x16x32_bf16 v[60:63], v[28:31], a[88:91], v[60:63]
    ds_read_b64_tr_b16 v[26:27], v5 offset:37376
    v_mfma_f32_16x16x32_bf16 v[76:79], v[28:31], a[92:95], v[76:79]
    ds_read_b64_tr_b16 v[28:29], v5 offset:45056
    s_waitcnt lgkmcnt(3)
    v_mfma_f32_16x16x32_bf16 v[80:83], v[16:19], a[88:91], v[80:83]
    ds_read_b64_tr_b16 v[30:31], v5 offset:45568
    v_add_u32 v2, 0xffff0000, v2
    v_mfma_f32_16x16x32_bf16 v[96:99], v[16:19], a[92:95], v[96:99]
    s_barrier
    ds_read_b64_tr_b16 v[16:17], v2 offset:49152
    v_mfma_f32_16x16x32_bf16 v[88:91], v[20:23], a[88:91], v[88:91]
    ds_read_b64_tr_b16 v[18:19], v2 offset:49664
    v_mfma_f32_16x16x32_bf16 v[104:107], v[20:23], a[92:95], v[104:107]
    ds_read_b64_tr_b16 v[20:21], v2 offset:57344
    s_waitcnt lgkmcnt(3)
    v_mfma_f32_16x16x32_bf16 v[84:87], v[24:27], a[88:91], v[84:87]
    ds_read_b64_tr_b16 v[22:23], v2 offset:57856
    v_add_u32 v3, 0xffff0000, v3
    v_mfma_f32_16x16x32_bf16 v[100:103], v[24:27], a[92:95], v[100:103]
    ds_read_b64_tr_b16 v[24:25], v3 offset:49152
    v_mfma_f32_16x16x32_bf16 v[92:95], v[28:31], a[88:91], v[92:95]
    ds_read_b64_tr_b16 v[26:27], v3 offset:49664
    v_mfma_f32_16x16x32_bf16 v[108:111], v[28:31], a[92:95], v[108:111]
    ds_read_b64_tr_b16 v[28:29], v3 offset:57344
    s_waitcnt lgkmcnt(3)
    v_mfma_f32_16x16x32_bf16 v[48:51], v[16:19], a[96:99], v[48:51]
    ds_read_b64_tr_b16 v[30:31], v3 offset:57856
    v_add_u32 v4, 0xffff0000, v4
    v_mfma_f32_16x16x32_bf16 v[64:67], v[16:19], a[100:103], v[64:67]
    ds_read_b64_tr_b16 v[16:17], v4 offset:49152
    v_mfma_f32_16x16x32_bf16 v[56:59], v[20:23], a[96:99], v[56:59]
    ds_read_b64_tr_b16 v[18:19], v4 offset:49664
    v_mfma_f32_16x16x32_bf16 v[72:75], v[20:23], a[100:103], v[72:75]
    ds_read_b64_tr_b16 v[20:21], v4 offset:57344
    s_waitcnt lgkmcnt(3)
    v_mfma_f32_16x16x32_bf16 v[52:55], v[24:27], a[96:99], v[52:55]
    ds_read_b64_tr_b16 v[22:23], v4 offset:57856
    v_add_u32 v5, 0xffff0000, v5
    v_mfma_f32_16x16x32_bf16 v[68:71], v[24:27], a[100:103], v[68:71]
    ds_read_b64_tr_b16 v[24:25], v5 offset:49152
    v_mfma_f32_16x16x32_bf16 v[60:63], v[28:31], a[96:99], v[60:63]
    ds_read_b64_tr_b16 v[26:27], v5 offset:49664
    v_mfma_f32_16x16x32_bf16 v[76:79], v[28:31], a[100:103], v[76:79]
    ds_read_b64_tr_b16 v[28:29], v5 offset:57344
    s_waitcnt lgkmcnt(3)
    v_mfma_f32_16x16x32_bf16 v[80:83], v[16:19], a[96:99], v[80:83]
    ds_read_b64_tr_b16 v[30:31], v5 offset:57856
    v_mfma_f32_16x16x32_bf16 v[96:99], v[16:19], a[100:103], v[96:99]
    ds_read_b64_tr_b16 v[16:17], v2 offset:53248
    v_mfma_f32_16x16x32_bf16 v[88:91], v[20:23], a[96:99], v[88:91]
    ds_read_b64_tr_b16 v[18:19], v2 offset:53760
    v_mfma_f32_16x16x32_bf16 v[104:107], v[20:23], a[100:103], v[104:107]
    ds_read_b64_tr_b16 v[20:21], v2 offset:61440
    s_waitcnt lgkmcnt(3)
    v_mfma_f32_16x16x32_bf16 v[84:87], v[24:27], a[96:99], v[84:87]
    ds_read_b64_tr_b16 v[22:23], v2 offset:61952
    v_mfma_f32_16x16x32_bf16 v[100:103], v[24:27], a[100:103], v[100:103]
    ds_read_b64_tr_b16 v[24:25], v3 offset:53248
    v_mfma_f32_16x16x32_bf16 v[92:95], v[28:31], a[96:99], v[92:95]
    ds_read_b64_tr_b16 v[26:27], v3 offset:53760
    v_mfma_f32_16x16x32_bf16 v[108:111], v[28:31], a[100:103], v[108:111]
    ds_read_b64_tr_b16 v[28:29], v3 offset:61440
    s_waitcnt lgkmcnt(3)
    v_mfma_f32_16x16x32_bf16 v[48:51], v[16:19], a[104:107], v[48:51]
    ds_read_b64_tr_b16 v[30:31], v3 offset:61952
    v_mfma_f32_16x16x32_bf16 v[64:67], v[16:19], a[108:111], v[64:67]
    ds_read_b64_tr_b16 v[16:17], v4 offset:53248
    v_mfma_f32_16x16x32_bf16 v[56:59], v[20:23], a[104:107], v[56:59]
    ds_read_b64_tr_b16 v[18:19], v4 offset:53760
    v_mfma_f32_16x16x32_bf16 v[72:75], v[20:23], a[108:111], v[72:75]
    ds_read_b64_tr_b16 v[20:21], v4 offset:61440
    s_waitcnt lgkmcnt(3)
    v_mfma_f32_16x16x32_bf16 v[52:55], v[24:27], a[104:107], v[52:55]
    ds_read_b64_tr_b16 v[22:23], v4 offset:61952
    v_mfma_f32_16x16x32_bf16 v[68:71], v[24:27], a[108:111], v[68:71]
    ds_read_b64_tr_b16 v[24:25], v5 offset:53248
    v_mfma_f32_16x16x32_bf16 v[60:63], v[28:31], a[104:107], v[60:63]
    ds_read_b64_tr_b16 v[26:27], v5 offset:53760
    v_mfma_f32_16x16x32_bf16 v[76:79], v[28:31], a[108:111], v[76:79]
    ds_read_b64_tr_b16 v[28:29], v5 offset:61440
    s_waitcnt lgkmcnt(3)
    v_mfma_f32_16x16x32_bf16 v[80:83], v[16:19], a[104:107], v[80:83]
    ds_read_b64_tr_b16 v[30:31], v5 offset:61952
    v_add_u32 v2, 0x10000, v2
    v_mfma_f32_16x16x32_bf16 v[96:99], v[16:19], a[108:111], v[96:99]
    s_barrier
    ds_read_b64_tr_b16 v[16:17], v2 offset:49152
    v_mfma_f32_16x16x32_bf16 v[88:91], v[20:23], a[104:107], v[88:91]
    ds_read_b64_tr_b16 v[18:19], v2 offset:49664
    v_mfma_f32_16x16x32_bf16 v[104:107], v[20:23], a[108:111], v[104:107]
    ds_read_b64_tr_b16 v[20:21], v2 offset:57344
    s_waitcnt lgkmcnt(3)
    v_mfma_f32_16x16x32_bf16 v[84:87], v[24:27], a[104:107], v[84:87]
    ds_read_b64_tr_b16 v[22:23], v2 offset:57856
    v_add_u32 v3, 0x10000, v3
    v_mfma_f32_16x16x32_bf16 v[100:103], v[24:27], a[108:111], v[100:103]
    ds_read_b64_tr_b16 v[24:25], v3 offset:49152
    v_mfma_f32_16x16x32_bf16 v[92:95], v[28:31], a[104:107], v[92:95]
    ds_read_b64_tr_b16 v[26:27], v3 offset:49664
    v_mfma_f32_16x16x32_bf16 v[108:111], v[28:31], a[108:111], v[108:111]
    ds_read_b64_tr_b16 v[28:29], v3 offset:57344
    s_waitcnt lgkmcnt(3)
    v_mfma_f32_16x16x32_bf16 v[48:51], v[16:19], a[112:115], v[48:51]
    ds_read_b64_tr_b16 v[30:31], v3 offset:57856
    v_add_u32 v4, 0x10000, v4
    v_mfma_f32_16x16x32_bf16 v[64:67], v[16:19], a[116:119], v[64:67]
    ds_read_b64_tr_b16 v[16:17], v4 offset:49152
    v_mfma_f32_16x16x32_bf16 v[56:59], v[20:23], a[112:115], v[56:59]
    ds_read_b64_tr_b16 v[18:19], v4 offset:49664
    v_mfma_f32_16x16x32_bf16 v[72:75], v[20:23], a[116:119], v[72:75]
    ds_read_b64_tr_b16 v[20:21], v4 offset:57344
    s_waitcnt lgkmcnt(3)
    v_mfma_f32_16x16x32_bf16 v[52:55], v[24:27], a[112:115], v[52:55]
    ds_read_b64_tr_b16 v[22:23], v4 offset:57856
    v_add_u32 v5, 0x10000, v5
    v_mfma_f32_16x16x32_bf16 v[68:71], v[24:27], a[116:119], v[68:71]
    ds_read_b64_tr_b16 v[24:25], v5 offset:49152
    v_mfma_f32_16x16x32_bf16 v[60:63], v[28:31], a[112:115], v[60:63]
    ds_read_b64_tr_b16 v[26:27], v5 offset:49664
    v_mfma_f32_16x16x32_bf16 v[76:79], v[28:31], a[116:119], v[76:79]
    ds_read_b64_tr_b16 v[28:29], v5 offset:57344
    s_waitcnt lgkmcnt(3)
    v_mfma_f32_16x16x32_bf16 v[80:83], v[16:19], a[112:115], v[80:83]
    ds_read_b64_tr_b16 v[30:31], v5 offset:57856
    v_mfma_f32_16x16x32_bf16 v[96:99], v[16:19], a[116:119], v[96:99]
    ds_read_b64_tr_b16 v[16:17], v2 offset:53248
    v_mfma_f32_16x16x32_bf16 v[88:91], v[20:23], a[112:115], v[88:91]
    ds_read_b64_tr_b16 v[18:19], v2 offset:53760
    v_mfma_f32_16x16x32_bf16 v[104:107], v[20:23], a[116:119], v[104:107]
    ds_read_b64_tr_b16 v[20:21], v2 offset:61440
    s_waitcnt lgkmcnt(3)
    v_mfma_f32_16x16x32_bf16 v[84:87], v[24:27], a[112:115], v[84:87]
    ds_read_b64_tr_b16 v[22:23], v2 offset:61952
    v_mfma_f32_16x16x32_bf16 v[100:103], v[24:27], a[116:119], v[100:103]
    ds_read_b64_tr_b16 v[24:25], v3 offset:53248
    v_mfma_f32_16x16x32_bf16 v[92:95], v[28:31], a[112:115], v[92:95]
    ds_read_b64_tr_b16 v[26:27], v3 offset:53760
    v_mfma_f32_16x16x32_bf16 v[108:111], v[28:31], a[116:119], v[108:111]
    ds_read_b64_tr_b16 v[28:29], v3 offset:61440
    s_waitcnt lgkmcnt(3)
    v_mfma_f32_16x16x32_bf16 v[48:51], v[16:19], a[120:123], v[48:51]
    ds_read_b64_tr_b16 v[30:31], v3 offset:61952
    v_mfma_f32_16x16x32_bf16 v[64:67], v[16:19], a[124:127], v[64:67]
    ds_read_b64_tr_b16 v[16:17], v4 offset:53248
    v_mfma_f32_16x16x32_bf16 v[56:59], v[20:23], a[120:123], v[56:59]
    ds_read_b64_tr_b16 v[18:19], v4 offset:53760
    v_mfma_f32_16x16x32_bf16 v[72:75], v[20:23], a[124:127], v[72:75]
    ds_read_b64_tr_b16 v[20:21], v4 offset:61440
    s_waitcnt lgkmcnt(3)
    v_mfma_f32_16x16x32_bf16 v[52:55], v[24:27], a[120:123], v[52:55]
    ds_read_b64_tr_b16 v[22:23], v4 offset:61952
    v_mfma_f32_16x16x32_bf16 v[68:71], v[24:27], a[124:127], v[68:71]
    ds_read_b64_tr_b16 v[24:25], v5 offset:53248
    v_mfma_f32_16x16x32_bf16 v[60:63], v[28:31], a[120:123], v[60:63]
    ds_read_b64_tr_b16 v[26:27], v5 offset:53760
    v_mfma_f32_16x16x32_bf16 v[76:79], v[28:31], a[124:127], v[76:79]
    ds_read_b64_tr_b16 v[28:29], v5 offset:61440
    s_waitcnt lgkmcnt(3)
    v_mfma_f32_16x16x32_bf16 v[80:83], v[16:19], a[120:123], v[80:83]
    ds_read_b64_tr_b16 v[30:31], v5 offset:61952
    v_add_u32 v2, 0xffff0000, v2
    v_mfma_f32_16x16x32_bf16 v[96:99], v[16:19], a[124:127], v[96:99]
    s_barrier
    ds_read_b64_tr_b16 v[16:17], v2 offset:0
    v_mfma_f32_16x16x32_bf16 v[88:91], v[20:23], a[120:123], v[88:91]
    ds_read_b64_tr_b16 v[18:19], v2 offset:512
    v_mfma_f32_16x16x32_bf16 v[104:107], v[20:23], a[124:127], v[104:107]
    ds_read_b64_tr_b16 v[20:21], v2 offset:8192
    s_waitcnt lgkmcnt(3)
    v_mfma_f32_16x16x32_bf16 v[84:87], v[24:27], a[120:123], v[84:87]
    ds_read_b64_tr_b16 v[22:23], v2 offset:8704
    v_add_u32 v3, 0xffff0000, v3
    v_mfma_f32_16x16x32_bf16 v[100:103], v[24:27], a[124:127], v[100:103]
    ds_read_b64_tr_b16 v[24:25], v3 offset:0
    v_mfma_f32_16x16x32_bf16 v[92:95], v[28:31], a[120:123], v[92:95]
    ds_read_b64_tr_b16 v[26:27], v3 offset:512
    v_mfma_f32_16x16x32_bf16 v[108:111], v[28:31], a[124:127], v[108:111]
    ds_read_b64_tr_b16 v[28:29], v3 offset:8192
    s_waitcnt lgkmcnt(3)
    v_mfma_f32_16x16x32_bf16 v[48:51], v[16:19], a[128:131], v[48:51]
    ds_read_b64_tr_b16 v[30:31], v3 offset:8704
    v_add_u32 v4, 0xffff0000, v4
    v_mfma_f32_16x16x32_bf16 v[64:67], v[16:19], a[132:135], v[64:67]
    ds_read_b64_tr_b16 v[16:17], v4 offset:0
    v_mfma_f32_16x16x32_bf16 v[56:59], v[20:23], a[128:131], v[56:59]
    ds_read_b64_tr_b16 v[18:19], v4 offset:512
    v_mfma_f32_16x16x32_bf16 v[72:75], v[20:23], a[132:135], v[72:75]
    ds_read_b64_tr_b16 v[20:21], v4 offset:8192
    s_waitcnt lgkmcnt(3)
    v_mfma_f32_16x16x32_bf16 v[52:55], v[24:27], a[128:131], v[52:55]
    ds_read_b64_tr_b16 v[22:23], v4 offset:8704
    v_add_u32 v5, 0xffff0000, v5
    v_mfma_f32_16x16x32_bf16 v[68:71], v[24:27], a[132:135], v[68:71]
    ds_read_b64_tr_b16 v[24:25], v5 offset:0
    v_mfma_f32_16x16x32_bf16 v[60:63], v[28:31], a[128:131], v[60:63]
    ds_read_b64_tr_b16 v[26:27], v5 offset:512
    v_mfma_f32_16x16x32_bf16 v[76:79], v[28:31], a[132:135], v[76:79]
    ds_read_b64_tr_b16 v[28:29], v5 offset:8192
    s_waitcnt lgkmcnt(3)
    v_mfma_f32_16x16x32_bf16 v[80:83], v[16:19], a[128:131], v[80:83]
    ds_read_b64_tr_b16 v[30:31], v5 offset:8704
    v_mfma_f32_16x16x32_bf16 v[96:99], v[16:19], a[132:135], v[96:99]
    ds_read_b64_tr_b16 v[16:17], v2 offset:4096
    v_mfma_f32_16x16x32_bf16 v[88:91], v[20:23], a[128:131], v[88:91]
    ds_read_b64_tr_b16 v[18:19], v2 offset:4608
    v_mfma_f32_16x16x32_bf16 v[104:107], v[20:23], a[132:135], v[104:107]
    ds_read_b64_tr_b16 v[20:21], v2 offset:12288
    s_waitcnt lgkmcnt(3)
    v_mfma_f32_16x16x32_bf16 v[84:87], v[24:27], a[128:131], v[84:87]
    ds_read_b64_tr_b16 v[22:23], v2 offset:12800
    v_mfma_f32_16x16x32_bf16 v[100:103], v[24:27], a[132:135], v[100:103]
    ds_read_b64_tr_b16 v[24:25], v3 offset:4096
    v_mfma_f32_16x16x32_bf16 v[92:95], v[28:31], a[128:131], v[92:95]
    ds_read_b64_tr_b16 v[26:27], v3 offset:4608
    v_mfma_f32_16x16x32_bf16 v[108:111], v[28:31], a[132:135], v[108:111]
    ds_read_b64_tr_b16 v[28:29], v3 offset:12288
    s_waitcnt lgkmcnt(3)
    v_mfma_f32_16x16x32_bf16 v[48:51], v[16:19], a[136:139], v[48:51]
    ds_read_b64_tr_b16 v[30:31], v3 offset:12800
    v_mfma_f32_16x16x32_bf16 v[64:67], v[16:19], a[140:143], v[64:67]
    ds_read_b64_tr_b16 v[16:17], v4 offset:4096
    v_mfma_f32_16x16x32_bf16 v[56:59], v[20:23], a[136:139], v[56:59]
    ds_read_b64_tr_b16 v[18:19], v4 offset:4608
    v_mfma_f32_16x16x32_bf16 v[72:75], v[20:23], a[140:143], v[72:75]
    ds_read_b64_tr_b16 v[20:21], v4 offset:12288
    s_waitcnt lgkmcnt(3)
    v_mfma_f32_16x16x32_bf16 v[52:55], v[24:27], a[136:139], v[52:55]
    ds_read_b64_tr_b16 v[22:23], v4 offset:12800
    v_mfma_f32_16x16x32_bf16 v[68:71], v[24:27], a[140:143], v[68:71]
    ds_read_b64_tr_b16 v[24:25], v5 offset:4096
    v_mfma_f32_16x16x32_bf16 v[60:63], v[28:31], a[136:139], v[60:63]
    ds_read_b64_tr_b16 v[26:27], v5 offset:4608
    v_mfma_f32_16x16x32_bf16 v[76:79], v[28:31], a[140:143], v[76:79]
    ds_read_b64_tr_b16 v[28:29], v5 offset:12288
    s_waitcnt lgkmcnt(3)
    v_mfma_f32_16x16x32_bf16 v[80:83], v[16:19], a[136:139], v[80:83]
    ds_read_b64_tr_b16 v[30:31], v5 offset:12800
    v_mfma_f32_16x16x32_bf16 v[96:99], v[16:19], a[140:143], v[96:99]
    v_mfma_f32_16x16x32_bf16 v[88:91], v[20:23], a[136:139], v[88:91]
    v_mfma_f32_16x16x32_bf16 v[104:107], v[20:23], a[140:143], v[104:107]
    s_waitcnt lgkmcnt(0)
    v_mfma_f32_16x16x32_bf16 v[84:87], v[24:27], a[136:139], v[84:87]
    v_mfma_f32_16x16x32_bf16 v[100:103], v[24:27], a[140:143], v[100:103]
    v_mfma_f32_16x16x32_bf16 v[92:95], v[28:31], a[136:139], v[92:95]
    v_mfma_f32_16x16x32_bf16 v[108:111], v[28:31], a[140:143], v[108:111]
    s_setprio 3
    v_pk_mul_f32 v[8:9], v[64:65], v[64:65]
    v_pk_mul_f32 v[10:11], v[66:67], v[66:67]
    v_pk_mul_f32 v[12:13], v[68:69], v[68:69]
    v_pk_mul_f32 v[14:15], v[70:71], v[70:71]
    v_pk_fma_f32 v[8:9], v[8:9], s[56:57], v[6:7] op_sel:[0,0,1]
    v_pk_fma_f32 v[10:11], v[10:11], s[56:57], v[6:7] op_sel:[0,0,1]
    v_pk_fma_f32 v[12:13], v[12:13], s[56:57], v[6:7] op_sel:[0,0,1]
    v_pk_fma_f32 v[14:15], v[14:15], s[56:57], v[6:7] op_sel:[0,0,1]
    v_pk_mul_f32 v[8:9], v[8:9], v[64:65]
    v_pk_mul_f32 v[10:11], v[10:11], v[66:67]
    v_pk_mul_f32 v[12:13], v[12:13], v[68:69]
    v_pk_mul_f32 v[14:15], v[14:15], v[70:71]
    v_exp_f32 v8, v8
    v_exp_f32 v9, v9
    v_exp_f32 v10, v10
    v_exp_f32 v11, v11
    v_exp_f32 v12, v12
    v_exp_f32 v13, v13
    v_exp_f32 v14, v14
    v_exp_f32 v15, v15
    v_pk_add_f32 v[8:9], v[8:9], 1.0 op_sel_hi:[1,0]
    v_pk_add_f32 v[10:11], v[10:11], 1.0 op_sel_hi:[1,0]
    v_pk_add_f32 v[12:13], v[12:13], 1.0 op_sel_hi:[1,0]
    v_pk_add_f32 v[14:15], v[14:15], 1.0 op_sel_hi:[1,0]
    v_rcp_f32 v8, v8
    v_rcp_f32 v9, v9
    v_rcp_f32 v10, v10
    v_rcp_f32 v11, v11
    v_rcp_f32 v12, v12
    v_rcp_f32 v13, v13
    v_rcp_f32 v14, v14
    v_rcp_f32 v15, v15
    s_branch L_skippad3
.p2align 12
L_pad3:
    s_setpc_b64 s[50:51]
L_skippad3:
    v_pk_mul_f32 v[8:9], v[8:9], v[64:65]
    v_pk_mul_f32 v[10:11], v[10:11], v[66:67]
    v_pk_mul_f32 v[12:13], v[12:13], v[68:69]
    v_pk_mul_f32 v[14:15], v[14:15], v[70:71]
    v_pk_mul_f32 v[8:9], v[8:9], v[72:73]
    v_pk_mul_f32 v[10:11], v[10:11], v[74:75]
    v_pk_mul_f32 v[12:13], v[12:13], v[76:77]
    v_pk_mul_f32 v[14:15], v[14:15], v[78:79]
    v_cvt_pk_bf16_f32 v64, v8, v9
    v_cvt_pk_bf16_f32 v65, v10, v11
    v_cvt_pk_bf16_f32 v66, v12, v13
    v_cvt_pk_bf16_f32 v67, v14, v15
    buffer_store_dwordx4 v[64:67], v1, s[24:27], s13 offen sc1
    v_pk_mul_f32 v[8:9], v[48:49], v[48:49]
    v_pk_mul_f32 v[10:11], v[50:51], v[50:51]
    v_pk_mul_f32 v[12:13], v[52:53], v[52:53]
    v_pk_mul_f32 v[14:15], v[54:55], v[54:55]
    v_pk_fma_f32 v[8:9], v[8:9], s[56:57], v[6:7] op_sel:[0,0,1]
    v_pk_fma_f32 v[10:11], v[10:11], s[56:57], v[6:7] op_sel:[0,0,1]
    v_pk_fma_f32 v[12:13], v[12:13], s[56:57], v[6:7] op_sel:[0,0,1]
    v_pk_fma_f32 v[14:15], v[14:15], s[56:57], v[6:7] op_sel:[0,0,1]
    v_pk_mul_f32 v[8:9], v[8:9], v[48:49]
    v_pk_mul_f32 v[10:11], v[10:11], v[50:51]
    v_pk_mul_f32 v[12:13], v[12:13], v[52:53]
    v_pk_mul_f32 v[14:15], v[14:15], v[54:55]
    v_exp_f32 v8, v8
    v_exp_f32 v9, v9
    v_exp_f32 v10, v10
    v_exp_f32 v11, v11
    v_exp_f32 v12, v12
    v_exp_f32 v13, v13
    v_exp_f32 v14, v14
    v_exp_f32 v15, v15
    v_pk_add_f32 v[8:9], v[8:9], 1.0 op_sel_hi:[1,0]
    v_pk_add_f32 v[10:11], v[10:11], 1.0 op_sel_hi:[1,0]
    v_pk_add_f32 v[12:13], v[12:13], 1.0 op_sel_hi:[1,0]
    v_pk_add_f32 v[14:15], v[14:15], 1.0 op_sel_hi:[1,0]
    v_rcp_f32 v8, v8
    v_rcp_f32 v9, v9
    v_rcp_f32 v10, v10
    v_rcp_f32 v11, v11
    v_rcp_f32 v12, v12
    v_rcp_f32 v13, v13
    v_rcp_f32 v14, v14
    v_rcp_f32 v15, v15
    v_pk_mul_f32 v[8:9], v[8:9], v[48:49]
    v_pk_mul_f32 v[10:11], v[10:11], v[50:51]
    v_pk_mul_f32 v[12:13], v[12:13], v[52:53]
    v_pk_mul_f32 v[14:15], v[14:15], v[54:55]
    v_pk_mul_f32 v[8:9], v[8:9], v[56:57]
    v_pk_mul_f32 v[10:11], v[10:11], v[58:59]
    v_pk_mul_f32 v[12:13], v[12:13], v[60:61]
    v_pk_mul_f32 v[14:15], v[14:15], v[62:63]
    v_cvt_pk_bf16_f32 v68, v8, v9
    v_cvt_pk_bf16_f32 v69, v10, v11
    v_cvt_pk_bf16_f32 v70, v12, v13
    v_cvt_pk_bf16_f32 v71, v14, v15
    buffer_store_dwordx4 v[68:71], v1, s[24:27], s12 offen sc1
    v_pk_mul_f32 v[8:9], v[80:81], v[80:81]
    v_pk_mul_f32 v[10:11], v[82:83], v[82:83]
    v_pk_mul_f32 v[12:13], v[84:85], v[84:85]
    v_pk_mul_f32 v[14:15], v[86:87], v[86:87]
    v_pk_fma_f32 v[8:9], v[8:9], s[56:57], v[6:7] op_sel:[0,0,1]
    v_pk_fma_f32 v[10:11], v[10:11], s[56:57], v[6:7] op_sel:[0,0,1]
    v_pk_fma_f32 v[12:13], v[12:13], s[56:57], v[6:7] op_sel:[0,0,1]
    v_pk_fma_f32 v[14:15], v[14:15], s[56:57], v[6:7] op_sel:[0,0,1]
    v_pk_mul_f32 v[8:9], v[8:9], v[80:81]
    v_pk_mul_f32 v[10:11], v[10:11], v[82:83]
    v_pk_mul_f32 v[12:13], v[12:13], v[84:85]
    v_pk_mul_f32 v[14:15], v[14:15], v[86:87]
    v_exp_f32 v8, v8
    v_exp_f32 v9, v9
    v_exp_f32 v10, v10
    v_exp_f32 v11, v11
    v_exp_f32 v12, v12
    v_exp_f32 v13, v13
    v_exp_f32 v14, v14
    v_exp_f32 v15, v15
    v_pk_add_f32 v[8:9], v[8:9], 1.0 op_sel_hi:[1,0]
    v_pk_add_f32 v[10:11], v[10:11], 1.0 op_sel_hi:[1,0]
    v_pk_add_f32 v[12:13], v[12:13], 1.0 op_sel_hi:[1,0]
    v_pk_add_f32 v[14:15], v[14:15], 1.0 op_sel_hi:[1,0]
    v_rcp_f32 v8, v8
    v_rcp_f32 v9, v9
    v_rcp_f32 v10, v10
    v_rcp_f32 v11, v11
    v_rcp_f32 v12, v12
    v_rcp_f32 v13, v13
    v_rcp_f32 v14, v14
    v_rcp_f32 v15, v15
    v_pk_mul_f32 v[8:9], v[8:9], v[80:81]
    v_pk_mul_f32 v[10:11], v[10:11], v[82:83]
    v_pk_mul_f32 v[12:13], v[12:13], v[84:85]
    v_pk_mul_f32 v[14:15], v[14:15], v[86:87]
    v_pk_mul_f32 v[8:9], v[8:9], v[88:89]
    v_pk_mul_f32 v[10:11], v[10:11], v[90:91]
    v_pk_mul_f32 v[12:13], v[12:13], v[92:93]
    v_pk_mul_f32 v[14:15], v[14:15], v[94:95]
    v_cvt_pk_bf16_f32 v80, v8, v9
    v_cvt_pk_bf16_f32 v81, v10, v11
    v_cvt_pk_bf16_f32 v82, v12, v13
    v_cvt_pk_bf16_f32 v83, v14, v15
    buffer_store_dwordx4 v[80:83], v1, s[24:27], s14 offen sc1
    s_barrier
    v_lshrrev_b32 v8, 4, v0
    v_bfe_u32 v9, v0, 2, 2
    v_and_b32 v10, 3, v0
    v_lshlrev_b32 v10, 3, v10
    v_lshl_add_u32 v11, v8, 3, v9
    v_and_b32 v12, 1, v8
    v_lshl_add_u32 v11, v12, 2, v11
    v_lshl_add_u32 v72, v11, 5, v10
    v_xor_b32 v73, 128, v72
    ds_read_b64_tr_b16 v[16:17], v72 offset:32768
    ds_read_b64_tr_b16 v[18:19], v73 offset:32768
    ds_read_b64_tr_b16 v[20:21], v72 offset:34816
    ds_read_b64_tr_b16 v[22:23], v73 offset:34816
    ds_read_b64_tr_b16 v[24:25], v72 offset:33792
    ds_read_b64_tr_b16 v[26:27], v73 offset:33792
    v_pk_mul_f32 v[8:9], v[96:97], v[96:97]
    v_pk_mul_f32 v[10:11], v[98:99], v[98:99]
    v_pk_mul_f32 v[12:13], v[100:101], v[100:101]
    v_pk_mul_f32 v[14:15], v[102:103], v[102:103]
    v_pk_fma_f32 v[8:9], v[8:9], s[56:57], v[6:7] op_sel:[0,0,1]
    v_pk_fma_f32 v[10:11], v[10:11], s[56:57], v[6:7] op_sel:[0,0,1]
    v_pk_fma_f32 v[12:13], v[12:13], s[56:57], v[6:7] op_sel:[0,0,1]
    v_pk_fma_f32 v[14:15], v[14:15], s[56:57], v[6:7] op_sel:[0,0,1]
    v_pk_mul_f32 v[8:9], v[8:9], v[96:97]
    v_pk_mul_f32 v[10:11], v[10:11], v[98:99]
    v_pk_mul_f32 v[12:13], v[12:13], v[100:101]
    v_pk_mul_f32 v[14:15], v[14:15], v[102:103]
    v_exp_f32 v8, v8
    v_exp_f32 v9, v9
    v_exp_f32 v10, v10
    v_exp_f32 v11, v11
    v_exp_f32 v12, v12
    v_exp_f32 v13, v13
    v_exp_f32 v14, v14
    v_exp_f32 v15, v15
    v_pk_add_f32 v[8:9], v[8:9], 1.0 op_sel_hi:[1,0]
    v_pk_add_f32 v[10:11], v[10:11], 1.0 op_sel_hi:[1,0]
    v_pk_add_f32 v[12:13], v[12:13], 1.0 op_sel_hi:[1,0]
    v_pk_add_f32 v[14:15], v[14:15], 1.0 op_sel_hi:[1,0]
    v_rcp_f32 v8, v8
    v_rcp_f32 v9, v9
    v_rcp_f32 v10, v10
    v_rcp_f32 v11, v11
    v_rcp_f32 v12, v12
    v_rcp_f32 v13, v13
    v_rcp_f32 v14, v14
    v_rcp_f32 v15, v15
    v_pk_mul_f32 v[8:9], v[8:9], v[96:97]
    v_pk_mul_f32 v[10:11], v[10:11], v[98:99]
    v_pk_mul_f32 v[12:13], v[12:13], v[100:101]
    v_pk_mul_f32 v[14:15], v[14:15], v[102:103]
    v_pk_mul_f32 v[8:9], v[8:9], v[104:105]
    v_pk_mul_f32 v[10:11], v[10:11], v[106:107]
    v_pk_mul_f32 v[12:13], v[12:13], v[108:109]
    v_pk_mul_f32 v[14:15], v[14:15], v[110:111]
    v_cvt_pk_bf16_f32 v96, v8, v9
    v_cvt_pk_bf16_f32 v97, v10, v11
    v_cvt_pk_bf16_f32 v98, v12, v13
    v_cvt_pk_bf16_f32 v99, v14, v15
    buffer_store_dwordx4 v[96:99], v1, s[24:27], s15 offen sc1
    s_setprio 0
    ds_read_b64_tr_b16 v[28:29], v72 offset:35840
    s_waitcnt lgkmcnt(3)
    v_mfma_f32_16x16x32_bf16 v[48:51], v[16:19], a[0:3], 0
    ds_read_b64_tr_b16 v[30:31], v73 offset:35840
    v_mfma_f32_16x16x32_bf16 v[52:55], v[16:19], a[4:7], 0
    ds_read_b64_tr_b16 v[16:17], v72 offset:36864
    v_mfma_f32_16x16x32_bf16 v[56:59], v[20:23], a[0:3], 0
    ds_read_b64_tr_b16 v[18:19], v73 offset:36864
    v_lshrrev_b32 v8, 4, v0
    v_mfma_f32_16x16x32_bf16 v[60:63], v[20:23], a[4:7], 0
    ds_read_b64_tr_b16 v[20:21], v72 offset:38912
    s_waitcnt lgkmcnt(3)
    v_mfma_f32_16x16x32_bf16 v[48:51], v[24:27], a[8:11], v[48:51]
    ds_read_b64_tr_b16 v[22:23], v73 offset:38912
    v_bfe_u32 v9, v0, 2, 2
    v_mfma_f32_16x16x32_bf16 v[52:55], v[24:27], a[12:15], v[52:55]
    ds_read_b64_tr_b16 v[24:25], v72 offset:37888
    v_mfma_f32_16x16x32_bf16 v[56:59], v[28:31], a[8:11], v[56:59]
    ds_read_b64_tr_b16 v[26:27], v73 offset:37888
    v_and_b32 v10, 3, v0
    v_mfma_f32_16x16x32_bf16 v[60:63], v[28:31], a[12:15], v[60:63]
    ds_read_b64_tr_b16 v[28:29], v72 offset:39936
    s_waitcnt lgkmcnt(3)
    v_mfma_f32_16x16x32_bf16 v[48:51], v[16:19], a[16:19], v[48:51]
    ds_read_b64_tr_b16 v[30:31], v73 offset:39936
    v_lshlrev_b32 v10, 3, v10
    v_mfma_f32_16x16x32_bf16 v[52:55], v[16:19], a[20:23], v[52:55]
    ds_read_b64_tr_b16 v[16:17], v72 offset:40960
    v_mfma_f32_16x16x32_bf16 v[56:59], v[20:23], a[16:19], v[56:59]
    ds_read_b64_tr_b16 v[18:19], v73 offset:40960
    v_lshl_add_u32 v11, v8, 2, v9
    v_mfma_f32_16x16x32_bf16 v[60:63], v[20:23], a[20:23], v[60:63]
    ds_read_b64_tr_b16 v[20:21], v72 offset:43008
    s_waitcnt lgkmcnt(3)
    v_mfma_f32_16x16x32_bf16 v[48:51], v[24:27], a[24:27], v[48:51]
    ds_read_b64_tr_b16 v[22:23], v73 offset:43008
    v_lshl_add_u32 v2, v11, 7, v10
    v_mfma_f32_16x16x32_bf16 v[52:55], v[24:27], a[28:31], v[52:55]
    ds_read_b64_tr_b16 v[24:25], v72 offset:41984
    v_mfma_f32_16x16x32_bf16 v[56:59], v[28:31], a[24:27], v[56:59]
    ds_read_b64_tr_b16 v[26:27], v73 offset:41984
    v_bfe_u32 v11, v11, 1, 2
    v_mfma_f32_16x16x32_bf16 v[60:63], v[28:31], a[28:31], v[60:63]
    ds_read_b64_tr_b16 v[28:29], v72 offset:44032
    s_waitcnt lgkmcnt(3)
    v_mfma_f32_16x16x32_bf16 v[48:51], v[16:19], a[32:35], v[48:51]
    ds_read_b64_tr_b16 v[30:31], v73 offset:44032
    v_lshl_add_u32 v2, v11, 5, v2
    v_mfma_f32_16x16x32_bf16 v[52:55], v[16:19], a[36:39], v[52:55]
    s_barrier
    v_add_u32 v72, 0x10000, v72
    v_add_u32 v73, 0x10000, v73
    ds_read_b64_tr_b16 v[16:17], v72 offset:32768
    v_mfma_f32_16x16x32_bf16 v[56:59], v[20:23], a[32:35], v[56:59]
    ds_read_b64_tr_b16 v[18:19], v73 offset:32768
    v_add_u32 v2, 0x10000, v2
    v_mfma_f32_16x16x32_bf16 v[60:63], v[20:23], a[36:39], v[60:63]
    ds_read_b64_tr_b16 v[20:21], v72 offset:34816
    s_waitcnt lgkmcnt(3)
    v_mfma_f32_16x16x32_bf16 v[48:51], v[24:27], a[40:43], v[48:51]
    ds_read_b64_tr_b16 v[22:23], v73 offset:34816
    v_xor_b32 v3, 32, v2
    v_mfma_f32_16x16x32_bf16 v[52:55], v[24:27], a[44:47], v[52:55]
    ds_read_b64_tr_b16 v[24:25], v72 offset:33792
    v_mfma_f32_16x16x32_bf16 v[56:59], v[28:31], a[40:43], v[56:59]
    ds_read_b64_tr_b16 v[26:27], v73 offset:33792
    v_xor_b32 v4, 64, v2
    v_mfma_f32_16x16x32_bf16 v[60:63], v[28:31], a[44:47], v[60:63]
    ds_read_b64_tr_b16 v[28:29], v72 offset:35840
    s_waitcnt lgkmcnt(3)
    v_mfma_f32_16x16x32_bf16 v[48:51], v[16:19], a[48:51], v[48:51]
    ds_read_b64_tr_b16 v[30:31], v73 offset:35840
    v_xor_b32 v5, 96, v2
    v_mfma_f32_16x16x32_bf16 v[52:55], v[16:19], a[52:55], v[52:55]
    ds_read_b64_tr_b16 v[16:17], v72 offset:36864
    v_mfma_f32_16x16x32_bf16 v[56:59], v[20:23], a[48:51], v[56:59]
    ds_read_b64_tr_b16 v[18:19], v73 offset:36864
    v_add_u32 v6, s31, v1
    v_mfma_f32_16x16x32_bf16 v[60:63], v[20:23], a[52:55], v[60:63]
    ds_read_b64_tr_b16 v[20:21], v72 offset:38912
    s_waitcnt lgkmcnt(3)
    v_mfma_f32_16x16x32_bf16 v[48:51], v[24:27], a[56:59], v[48:51]
    ds_read_b64_tr_b16 v[22:23], v73 offset:38912
    v_mfma_f32_16x16x32_bf16 v[52:55], v[24:27], a[60:63], v[52:55]
    ds_read_b64_tr_b16 v[24:25], v72 offset:37888
    v_mfma_f32_16x16x32_bf16 v[56:59], v[28:31], a[56:59], v[56:59]
    ds_read_b64_tr_b16 v[26:27], v73 offset:37888
    v_mfma_f32_16x16x32_bf16 v[60:63], v[28:31], a[60:63], v[60:63]
    ds_read_b64_tr_b16 v[28:29], v72 offset:39936
    s_waitcnt lgkmcnt(3)
    v_mfma_f32_16x16x32_bf16 v[48:51], v[16:19], a[64:67], v[48:51]
    ds_read_b64_tr_b16 v[30:31], v73 offset:39936
    v_mfma_f32_16x16x32_bf16 v[52:55], v[16:19], a[68:71], v[52:55]
    ds_read_b64_tr_b16 v[16:17], v72 offset:40960
    v_mfma_f32_16x16x32_bf16 v[56:59], v[20:23], a[64:67], v[56:59]
    ds_read_b64_tr_b16 v[18:19], v73 offset:40960
    v_mfma_f32_16x16x32_bf16 v[60:63], v[20:23], a[68:71], v[60:63]
    ds_read_b64_tr_b16 v[20:21], v72 offset:43008
    s_waitcnt lgkmcnt(3)
    v_mfma_f32_16x16x32_bf16 v[48:51], v[24:27], a[72:75], v[48:51]
    ds_read_b64_tr_b16 v[22:23], v73 offset:43008
    v_mfma_f32_16x16x32_bf16 v[52:55], v[24:27], a[76:79], v[52:55]
    ds_read_b64_tr_b16 v[24:25], v72 offset:41984
    v_mfma_f32_16x16x32_bf16 v[56:59], v[28:31], a[72:75], v[56:59]
    ds_read_b64_tr_b16 v[26:27], v73 offset:41984
    v_accvgpr_write_b32 a16, v68
    v_mfma_f32_16x16x32_bf16 v[60:63], v[28:31], a[76:79], v[60:63]
    ds_read_b64_tr_b16 v[28:29], v72 offset:44032
    s_waitcnt lgkmcnt(3)
    v_mfma_f32_16x16x32_bf16 v[48:51], v[16:19], a[80:83], v[48:51]
    ds_read_b64_tr_b16 v[30:31], v73 offset:44032
    v_accvgpr_write_b32 a17, v69
    v_mfma_f32_16x16x32_bf16 v[52:55], v[16:19], a[84:87], v[52:55]
    s_waitcnt vmcnt(0)
    s_barrier
    v_add_u32 v72, 0xffff0000, v72
    v_add_u32 v73, 0xffff0000, v73
    ds_read_b64_tr_b16 v[16:17], v72 offset:49152
    v_mfma_f32_16x16x32_bf16 v[56:59], v[20:23], a[80:83], v[56:59]
    ds_read_b64_tr_b16 v[18:19], v73 offset:49152
    v_accvgpr_write_b32 a18, v70
    v_mfma_f32_16x16x32_bf16 v[60:63], v[20:23], a[84:87], v[60:63]
    ds_read_b64_tr_b16 v[20:21], v72 offset:51200
    s_waitcnt lgkmcnt(3)
    v_mfma_f32_16x16x32_bf16 v[48:51], v[24:27], a[88:91], v[48:51]
    ds_read_b64_tr_b16 v[22:23], v73 offset:51200
    v_accvgpr_write_b32 a19, v71
    v_mfma_f32_16x16x32_bf16 v[52:55], v[24:27], a[92:95], v[52:55]
    ds_read_b64_tr_b16 v[24:25], v72 offset:50176
    v_mfma_f32_16x16x32_bf16 v[56:59], v[28:31], a[88:91], v[56:59]
    ds_read_b64_tr_b16 v[26:27], v73 offset:50176
    v_accvgpr_write_b32 a20, v64
    v_mfma_f32_16x16x32_bf16 v[60:63], v[28:31], a[92:95], v[60:63]
    ds_read_b64_tr_b16 v[28:29], v72 offset:52224
    s_waitcnt lgkmcnt(3)
    v_mfma_f32_16x16x32_bf16 v[48:51], v[16:19], a[96:99], v[48:51]
    ds_read_b64_tr_b16 v[30:31], v73 offset:52224
    v_accvgpr_write_b32 a21, v65
    v_mfma_f32_16x16x32_bf16 v[52:55], v[16:19], a[100:103], v[52:55]
    ds_read_b64_tr_b16 v[16:17], v72 offset:53248
    v_mfma_f32_16x16x32_bf16 v[56:59], v[20:23], a[96:99], v[56:59]
    ds_read_b64_tr_b16 v[18:19], v73 offset:53248
    v_accvgpr_write_b32 a22, v66
    v_mfma_f32_16x16x32_bf16 v[60:63], v[20:23], a[100:103], v[60:63]
    ds_read_b64_tr_b16 v[20:21], v72 offset:55296
    s_waitcnt lgkmcnt(3)
    v_mfma_f32_16x16x32_bf16 v[48:51], v[24:27], a[104:107], v[48:51]
    ds_read_b64_tr_b16 v[22:23], v73 offset:55296
    v_accvgpr_write_b32 a23, v67
    v_mfma_f32_16x16x32_bf16 v[52:55], v[24:27], a[108:111], v[52:55]
    ds_read_b64_tr_b16 v[24:25], v72 offset:54272
    v_mfma_f32_16x16x32_bf16 v[56:59], v[28:31], a[104:107], v[56:59]
    ds_read_b64_tr_b16 v[26:27], v73 offset:54272
    v_accvgpr_write_b32 a24, v80
    v_mfma_f32_16x16x32_bf16 v[60:63], v[28:31], a[108:111], v[60:63]
    ds_read_b64_tr_b16 v[28:29], v72 offset:56320
    s_waitcnt lgkmcnt(3)
    v_mfma_f32_16x16x32_bf16 v[48:51], v[16:19], a[112:115], v[48:51]
    ds_read_b64_tr_b16 v[30:31], v73 offset:56320
    v_accvgpr_write_b32 a25, v81
    v_mfma_f32_16x16x32_bf16 v[52:55], v[16:19], a[116:119], v[52:55]
    ds_read_b64_tr_b16 v[16:17], v72 offset:57344
    v_mfma_f32_16x16x32_bf16 v[56:59], v[20:23], a[112:115], v[56:59]
    ds_read_b64_tr_b16 v[18:19], v73 offset:57344
    v_accvgpr_write_b32 a26, v82
    v_mfma_f32_16x16x32_bf16 v[60:63], v[20:23], a[116:119], v[60:63]
    ds_read_b64_tr_b16 v[20:21], v72 offset:59392
    s_waitcnt lgkmcnt(3)
    v_mfma_f32_16x16x32_bf16 v[48:51], v[24:27], a[120:123], v[48:51]
    ds_read_b64_tr_b16 v[22:23], v73 offset:59392
    v_accvgpr_write_b32 a27, v83
    v_mfma_f32_16x16x32_bf16 v[52:55], v[24:27], a[124:127], v[52:55]
    ds_read_b64_tr_b16 v[24:25], v72 offset:58368
    v_mfma_f32_16x16x32_bf16 v[56:59], v[28:31], a[120:123], v[56:59]
    ds_read_b64_tr_b16 v[26:27], v73 offset:58368
    v_accvgpr_write_b32 a28, v96
    v_mfma_f32_16x16x32_bf16 v[60:63], v[28:31], a[124:127], v[60:63]
    ds_read_b64_tr_b16 v[28:29], v72 offset:60416
    s_waitcnt lgkmcnt(3)
    v_mfma_f32_16x16x32_bf16 v[48:51], v[16:19], a[128:131], v[48:51]
    ds_read_b64_tr_b16 v[30:31], v73 offset:60416
    v_accvgpr_write_b32 a29, v97
    v_mfma_f32_16x16x32_bf16 v[52:55], v[16:19], a[132:135], v[52:55]
    v_mfma_f32_16x16x32_bf16 v[56:59], v[20:23], a[128:131], v[56:59]
    v_accvgpr_write_b32 a30, v98
    v_mfma_f32_16x16x32_bf16 v[60:63], v[20:23], a[132:135], v[60:63]
    s_waitcnt lgkmcnt(0)
    v_mfma_f32_16x16x32_bf16 v[48:51], v[24:27], a[136:139], v[48:51]
    v_accvgpr_write_b32 a31, v99
    v_mfma_f32_16x16x32_bf16 v[52:55], v[24:27], a[140:143], v[52:55]
    v_mfma_f32_16x16x32_bf16 v[56:59], v[28:31], a[136:139], v[56:59]
    v_mfma_f32_16x16x32_bf16 v[60:63], v[28:31], a[140:143], v[60:63]
    s_setprio 3
    s_barrier
    ds_read_b64_tr_b16 v[16:17], v2 offset:0
    ds_read_b64_tr_b16 v[18:19], v2 offset:2048
    ds_read_b64_tr_b16 v[20:21], v3 offset:0
    ds_read_b64_tr_b16 v[22:23], v3 offset:2048
    ds_read_b64_tr_b16 v[24:25], v4 offset:0
    ds_read_b64_tr_b16 v[26:27], v4 offset:2048
    v_pk_mul_f32 v[8:9], v[48:49], v[48:49]
    v_pk_mul_f32 v[10:11], v[50:51], v[50:51]
    v_pk_mul_f32 v[12:13], v[52:53], v[52:53]
    v_pk_mul_f32 v[14:15], v[54:55], v[54:55]
    v_pk_fma_f32 v[8:9], v[8:9], s[56:57], v[6:7] op_sel:[0,0,1]
    v_pk_fma_f32 v[10:11], v[10:11], s[56:57], v[6:7] op_sel:[0,0,1]
    v_pk_fma_f32 v[12:13], v[12:13], s[56:57], v[6:7] op_sel:[0,0,1]
    v_pk_fma_f32 v[14:15], v[14:15], s[56:57], v[6:7] op_sel:[0,0,1]
    v_pk_mul_f32 v[8:9], v[8:9], v[48:49]
    v_pk_mul_f32 v[10:11], v[10:11], v[50:51]
    v_pk_mul_f32 v[12:13], v[12:13], v[52:53]
    v_pk_mul_f32 v[14:15], v[14:15], v[54:55]
    v_exp_f32 v8, v8
    v_exp_f32 v9, v9
    v_exp_f32 v10, v10
    v_exp_f32 v11, v11
    v_exp_f32 v12, v12
    v_exp_f32 v13, v13
    v_exp_f32 v14, v14
    v_exp_f32 v15, v15
    v_pk_add_f32 v[8:9], v[8:9], 1.0 op_sel_hi:[1,0]
    v_pk_add_f32 v[10:11], v[10:11], 1.0 op_sel_hi:[1,0]
    v_pk_add_f32 v[12:13], v[12:13], 1.0 op_sel_hi:[1,0]
    v_pk_add_f32 v[14:15], v[14:15], 1.0 op_sel_hi:[1,0]
    v_rcp_f32 v8, v8
    v_rcp_f32 v9, v9
    v_rcp_f32 v10, v10
    v_rcp_f32 v11, v11
    v_rcp_f32 v12, v12
    v_rcp_f32 v13, v13
    v_rcp_f32 v14, v14
    v_rcp_f32 v15, v15
    v_pk_mul_f32 v[8:9], v[8:9], v[48:49]
    v_pk_mul_f32 v[10:11], v[10:11], v[50:51]
    v_pk_mul_f32 v[12:13], v[12:13], v[52:53]
    v_pk_mul_f32 v[14:15], v[14:15], v[54:55]
    v_pk_mul_f32 v[8:9], v[8:9], v[56:57]
    v_pk_mul_f32 v[10:11], v[10:11], v[58:59]
    v_pk_mul_f32 v[12:13], v[12:13], v[60:61]
    v_pk_mul_f32 v[14:15], v[14:15], v[62:63]
    v_cvt_pk_bf16_f32 v48, v8, v9
    v_cvt_pk_bf16_f32 v49, v10, v11
    v_cvt_pk_bf16_f32 v50, v12, v13
    v_cvt_pk_bf16_f32 v51, v14, v15
    buffer_store_dwordx4 v[48:51], v1, s[24:27], s16 offen sc1
    v_accvgpr_write_b32 a32, v48
    v_accvgpr_write_b32 a33, v49
    v_accvgpr_write_b32 a36, v50
    v_accvgpr_write_b32 a37, v51
    v_lshlrev_b32 v7, 3, v0
    s_setprio 0
    ds_read_b64_tr_b16 v[28:29], v5 offset:0
    s_waitcnt lgkmcnt(3)
    v_mfma_f32_16x16x32_bf16 v[48:51], v[16:19], v[32:35], 0
    ds_read_b64_tr_b16 v[30:31], v5 offset:2048
    v_add_u32 v6, 0x10000, v6
    ds_read_b128 a[96:99], v6 offset:16384
    v_mfma_f32_16x16x32_bf16 v[80:83], v[16:19], v[36:39], 0
    ds_read_b64_tr_b16 v[16:17], v2 offset:8192
    v_mfma_f32_16x16x32_bf16 v[52:55], v[20:23], v[32:35], 0
    ds_read_b64_tr_b16 v[18:19], v2 offset:10240
    ds_read_b128 a[100:103], v6 offset:17408
    v_mfma_f32_16x16x32_bf16 v[84:87], v[20:23], v[36:39], 0
    ds_read_b64_tr_b16 v[20:21], v3 offset:8192
    s_waitcnt lgkmcnt(5)
    v_mfma_f32_16x16x32_bf16 v[56:59], v[24:27], v[32:35], 0
    ds_read_b64_tr_b16 v[22:23], v3 offset:10240
    ds_read_b128 a[104:107], v6 offset:18432
    v_mfma_f32_16x16x32_bf16 v[88:91], v[24:27], v[36:39], 0
    ds_read_b64_tr_b16 v[24:25], v4 offset:8192
    v_mfma_f32_16x16x32_bf16 v[60:63], v[28:31], v[32:35], 0
    ds_read_b64_tr_b16 v[26:27], v4 offset:10240
    ds_read_b128 a[108:111], v6 offset:19456
    v_mfma_f32_16x16x32_bf16 v[92:95], v[28:31], v[36:39], 0
    ds_read_b64_tr_b16 v[28:29], v5 offset:8192
    s_waitcnt lgkmcnt(5)
    v_mfma_f32_16x16x32_bf16 v[64:67], v[16:19], v[32:35], 0
    ds_read_b64_tr_b16 v[30:31], v5 offset:10240
    ds_read_b128 a[112:115], v6 offset:49152
    v_mfma_f32_16x16x32_bf16 v[96:99], v[16:19], v[36:39], 0
    ds_read_b64_tr_b16 v[16:17], v7 offset:16384
    v_mfma_f32_16x16x32_bf16 v[68:71], v[20:23], v[32:35], 0
    ds_read_b64_tr_b16 v[18:19], v7 offset:16896
    ds_read_b128 a[116:119], v6 offset:50176
    v_mfma_f32_16x16x32_bf16 v[100:103], v[20:23], v[36:39], 0
    ds_read_b64_tr_b16 v[20:21], v2 offset:4096
    s_waitcnt lgkmcnt(5)
    v_mfma_f32_16x16x32_bf16 v[72:75], v[24:27], v[32:35], 0
    ds_read_b64_tr_b16 v[22:23], v2 offset:6144
    ds_read_b128 a[120:123], v6 offset:51200
    v_mfma_f32_16x16x32_bf16 v[104:107], v[24:27], v[36:39], 0
    ds_read_b64_tr_b16 v[24:25], v3 offset:4096
    v_mfma_f32_16x16x32_bf16 v[76:79], v[28:31], v[32:35], 0
    ds_read_b64_tr_b16 v[26:27], v3 offset:6144
    ds_read_b128 a[124:127], v6 offset:52224
    v_mfma_f32_16x16x32_bf16 v[108:111], v[28:31], v[36:39], 0
    ds_read_b64_tr_b16 v[28:29], v4 offset:4096
    s_waitcnt lgkmcnt(5)
    v_mfma_f32_16x16x32_bf16 v[8:11], v[16:19], v[32:35], 0
    ds_read_b64_tr_b16 v[30:31], v4 offset:6144
    v_mfma_f32_16x16x32_bf16 v[12:15], v[16:19], v[36:39], 0
    ds_read_b64_tr_b16 v[16:17], v5 offset:4096
    v_mfma_f32_16x16x32_bf16 v[48:51], v[20:23], v[40:43], v[48:51]
    ds_read_b64_tr_b16 v[18:19], v5 offset:6144
    v_mfma_f32_16x16x32_bf16 v[80:83], v[20:23], v[44:47], v[80:83]
    ds_read_b64_tr_b16 v[20:21], v2 offset:12288
    s_waitcnt lgkmcnt(3)
    v_mfma_f32_16x16x32_bf16 v[52:55], v[24:27], v[40:43], v[52:55]
    ds_read_b64_tr_b16 v[22:23], v2 offset:14336
    v_mfma_f32_16x16x32_bf16 v[84:87], v[24:27], v[44:47], v[84:87]
    ds_read_b64_tr_b16 v[24:25], v3 offset:12288
    v_mfma_f32_16x16x32_bf16 v[56:59], v[28:31], v[40:43], v[56:59]
    ds_read_b64_tr_b16 v[26:27], v3 offset:14336
    v_mfma_f32_16x16x32_bf16 v[88:91], v[28:31], v[44:47], v[88:91]
    ds_read_b64_tr_b16 v[28:29], v4 offset:12288
    s_waitcnt lgkmcnt(3)
    v_mfma_f32_16x16x32_bf16 v[60:63], v[16:19], v[40:43], v[60:63]
    ds_read_b64_tr_b16 v[30:31], v4 offset:14336
    v_mfma_f32_16x16x32_bf16 v[92:95], v[16:19], v[44:47], v[92:95]
    ds_read_b64_tr_b16 v[16:17], v5 offset:12288
    v_mfma_f32_16x16x32_bf16 v[64:67], v[20:23], v[40:43], v[64:67]
    ds_read_b64_tr_b16 v[18:19], v5 offset:14336
    v_add_u32 v5, 0x10000, v5
    v_mfma_f32_16x16x32_bf16 v[96:99], v[20:23], v[44:47], v[96:99]
    ds_read_b64_tr_b16 v[20:21], v7 offset:17408
    s_waitcnt lgkmcnt(3)
    v_mfma_f32_16x16x32_bf16 v[68:71], v[24:27], v[40:43], v[68:71]
    ds_read_b64_tr_b16 v[22:23], v7 offset:17920
    v_add_u32 v2, 0x10000, v2
    v_mfma_f32_16x16x32_bf16 v[100:103], v[24:27], v[44:47], v[100:103]
    s_waitcnt vmcnt(0)
    s_barrier
    ds_read_b64_tr_b16 v[24:25], v2 offset:0
    v_mfma_f32_16x16x32_bf16 v[72:75], v[28:31], v[40:43], v[72:75]
    ds_read_b64_tr_b16 v[26:27], v2 offset:2048
    v_add_u32 v3, 0x10000, v3
    v_mfma_f32_16x16x32_bf16 v[104:107], v[28:31], v[44:47], v[104:107]
    ds_read_b64_tr_b16 v[28:29], v3 offset:0
    s_waitcnt lgkmcnt(3)
    v_mfma_f32_16x16x32_bf16 v[76:79], v[16:19], v[40:43], v[76:79]
    ds_read_b64_tr_b16 v[30:31], v3 offset:2048
    v_add_u32 v4, 0x10000, v4
    v_mfma_f32_16x16x32_bf16 v[108:111], v[16:19], v[44:47], v[108:111]
    ds_read_b64_tr_b16 v[16:17], v4 offset:0
    v_mfma_f32_16x16x32_bf16 v[8:11], v[20:23], v[40:43], v[8:11]
    ds_read_b64_tr_b16 v[18:19], v4 offset:2048
    v_add_u32 v6, 0xffff0000, v6
    v_mfma_f32_16x16x32_bf16 v[12:15], v[20:23], v[44:47], v[12:15]
    ds_read_b64_tr_b16 v[20:21], v5 offset:0
    s_waitcnt lgkmcnt(3)
    v_mfma_f32_16x16x32_bf16 v[48:51], v[24:27], a[16:19], v[48:51]
    ds_read_b64_tr_b16 v[22:23], v5 offset:2048
    ds_read_b128 a[128:131], v6 offset:0
    v_mfma_f32_16x16x32_bf16 v[80:83], v[24:27], a[20:23], v[80:83]
    ds_read_b64_tr_b16 v[24:25], v2 offset:8192
    v_mfma_f32_16x16x32_bf16 v[52:55], v[28:31], a[16:19], v[52:55]
    ds_read_b64_tr_b16 v[26:27], v2 offset:10240
    ds_read_b128 a[132:135], v6 offset:1024
    v_mfma_f32_16x16x32_bf16 v[84:87], v[28:31], a[20:23], v[84:87]
    ds_read_b64_tr_b16 v[28:29], v3 offset:8192
    s_waitcnt lgkmcnt(5)
    v_mfma_f32_16x16x32_bf16 v[56:59], v[16:19], a[16:19], v[56:59]
    ds_read_b64_tr_b16 v[30:31], v3 offset:10240
    ds_read_b128 a[136:139], v6 offset:2048
    v_mfma_f32_16x16x32_bf16 v[88:91], v[16:19], a[20:23], v[88:91]
    ds_read_b64_tr_b16 v[16:17], v4 offset:8192
    v_mfma_f32_16x16x32_bf16 v[60:63], v[20:23], a[16:19], v[60:63]
    ds_read_b64_tr_b16 v[18:19], v4 offset:10240
    ds_read_b128 a[140:143], v6 offset:3072
    v_mfma_f32_16x16x32_bf16 v[92:95], v[20:23], a[20:23], v[92:95]
    ds_read_b64_tr_b16 v[20:21], v5 offset:8192
    s_waitcnt lgkmcnt(5)
    v_mfma_f32_16x16x32_bf16 v[64:67], v[24:27], a[16:19], v[64:67]
    ds_read_b64_tr_b16 v[22:23], v5 offset:10240
    v_mfma_f32_16x16x32_bf16 v[96:99], v[24:27], a[20:23], v[96:99]
    ds_read_b64_tr_b16 v[24:25], v7 offset:18432
    v_mfma_f32_16x16x32_bf16 v[68:71], v[28:31], a[16:19], v[68:71]
    ds_read_b64_tr_b16 v[26:27], v7 offset:18944
    v_mfma_f32_16x16x32_bf16 v[100:103], v[28:31], a[20:23], v[100:103]
    ds_read_b64_tr_b16 v[28:29], v2 offset:4096
    s_waitcnt lgkmcnt(3)
    v_mfma_f32_16x16x32_bf16 v[72:75], v[16:19], a[16:19], v[72:75]
    ds_read_b64_tr_b16 v[30:31], v2 offset:6144
    v_mfma_f32_16x16x32_bf16 v[104:107], v[16:19], a[20:23], v[104:107]
    ds_read_b64_tr_b16 v[16:17], v3 offset:4096
    v_mfma_f32_16x16x32_bf16 v[76:79], v[20:23], a[16:19], v[76:79]
    ds_read_b64_tr_b16 v[18:19], v3 offset:6144
    v_mfma_f32_16x16x32_bf16 v[108:111], v[20:23], a[20:23], v[108:111]
    ds_read_b64_tr_b16 v[20:21], v4 offset:4096
    s_waitcnt lgkmcnt(3)
    v_mfma_f32_16x16x32_bf16 v[8:11], v[24:27], a[16:19], v[8:11]
    ds_read_b64_tr_b16 v[22:23], v4 offset:6144
    v_mfma_f32_16x16x32_bf16 v[12:15], v[24:27], a[20:23], v[12:15]
    ds_read_b64_tr_b16 v[24:25], v5 offset:4096
    v_mfma_f32_16x16x32_bf16 v[48:51], v[28:31], a[24:27], v[48:51]
    ds_read_b64_tr_b16 v[26:27], v5 offset:6144
    v_mfma_f32_16x16x32_bf16 v[80:83], v[28:31], a[28:31], v[80:83]
    ds_read_b64_tr_b16 v[28:29], v2 offset:12288
    s_waitcnt lgkmcnt(3)
    v_mfma_f32_16x16x32_bf16 v[52:55], v[16:19], a[24:27], v[52:55]
    ds_read_b64_tr_b16 v[30:31], v2 offset:14336
    v_mfma_f32_16x16x32_bf16 v[84:87], v[16:19], a[28:31], v[84:87]
    ds_read_b64_tr_b16 v[16:17], v3 offset:12288
    v_mfma_f32_16x16x32_bf16 v[56:59], v[20:23], a[24:27], v[56:59]
    ds_read_b64_tr_b16 v[18:19], v3 offset:14336
    s_branch L_skippad4
.p2align 12
L_pad4:
    s_setpc_b64 s[50:51]
L_skippad4:
    v_mfma_f32_16x16x32_bf16 v[88:91], v[20:23], a[28:31], v[88:91]
    ds_read_b64_tr_b16 v[20:21], v4 offset:12288
    s_waitcnt lgkmcnt(3)
    v_mfma_f32_16x16x32_bf16 v[60:63], v[24:27], a[24:27], v[60:63]
    ds_read_b64_tr_b16 v[22:23], v4 offset:14336
    v_mfma_f32_16x16x32_bf16 v[92:95], v[24:27], a[28:31], v[92:95]
    ds_read_b64_tr_b16 v[24:25], v5 offset:12288
    v_mfma_f32_16x16x32_bf16 v[64:67], v[28:31], a[24:27], v[64:67]
    ds_read_b64_tr_b16 v[26:27], v5 offset:14336
    v_mfma_f32_16x16x32_bf16 v[96:99], v[28:31], a[28:31], v[96:99]
    ds_read_b64_tr_b16 v[28:29], v7 offset:19456
    s_waitcnt lgkmcnt(3)
    v_mfma_f32_16x16x32_bf16 v[68:71], v[16:19], a[24:27], v[68:71]
    ds_read_b64_tr_b16 v[30:31], v7 offset:19968
    v_mfma_f32_16x16x32_bf16 v[100:103], v[16:19], a[28:31], v[100:103]
    s_barrier
    ds_read_b64_tr_b16 v[16:17], v2 offset:16384
    v_mfma_f32_16x16x32_bf16 v[72:75], v[20:23], a[24:27], v[72:75]
    ds_read_b64_tr_b16 v[18:19], v2 offset:18432
    v_mfma_f32_16x16x32_bf16 v[104:107], v[20:23], a[28:31], v[104:107]
    ds_read_b64_tr_b16 v[20:21], v3 offset:16384
    s_waitcnt lgkmcnt(3)
    v_mfma_f32_16x16x32_bf16 v[76:79], v[24:27], a[24:27], v[76:79]
    ds_read_b64_tr_b16 v[22:23], v3 offset:18432
    v_mfma_f32_16x16x32_bf16 v[108:111], v[24:27], a[28:31], v[108:111]
    ds_read_b64_tr_b16 v[24:25], v4 offset:16384
    v_mfma_f32_16x16x32_bf16 v[8:11], v[28:31], a[24:27], v[8:11]
    ds_read_b64_tr_b16 v[26:27], v4 offset:18432
    v_mfma_f32_16x16x32_bf16 v[12:15], v[28:31], a[28:31], v[12:15]
    ds_read_b64_tr_b16 v[28:29], v5 offset:16384
    s_waitcnt lgkmcnt(3)
    v_mfma_f32_16x16x32_bf16 v[48:51], v[16:19], a[96:99], v[48:51]
    ds_read_b64_tr_b16 v[30:31], v5 offset:18432
    v_mfma_f32_16x16x32_bf16 v[80:83], v[16:19], a[100:103], v[80:83]
    ds_read_b64_tr_b16 v[16:17], v2 offset:24576
    v_mfma_f32_16x16x32_bf16 v[52:55], v[20:23], a[96:99], v[52:55]
    ds_read_b64_tr_b16 v[18:19], v2 offset:26624
    v_mfma_f32_16x16x32_bf16 v[84:87], v[20:23], a[100:103], v[84:87]
    ds_read_b64_tr_b16 v[20:21], v3 offset:24576
    s_waitcnt lgkmcnt(3)
    v_mfma_f32_16x16x32_bf16 v[56:59], v[24:27], a[96:99], v[56:59]
    ds_read_b64_tr_b16 v[22:23], v3 offset:26624
    v_mfma_f32_16x16x32_bf16 v[88:91], v[24:27], a[100:103], v[88:91]
    ds_read_b64_tr_b16 v[24:25], v4 offset:24576
    v_mfma_f32_16x16x32_bf16 v[60:63], v[28:31], a[96:99], v[60:63]
    ds_read_b64_tr_b16 v[26:27], v4 offset:26624
    v_mfma_f32_16x16x32_bf16 v[92:95], v[28:31], a[100:103], v[92:95]
    ds_read_b64_tr_b16 v[28:29], v5 offset:24576
    s_waitcnt lgkmcnt(3)
    v_mfma_f32_16x16x32_bf16 v[64:67], v[16:19], a[96:99], v[64:67]
    ds_read_b64_tr_b16 v[30:31], v5 offset:26624
    v_mfma_f32_16x16x32_bf16 v[96:99], v[16:19], a[100:103], v[96:99]
    ds_read_b64_tr_b16 v[16:17], v7 offset:20480
    v_mfma_f32_16x16x32_bf16 v[68:71], v[20:23], a[96:99], v[68:71]
    ds_read_b64_tr_b16 v[18:19], v7 offset:20992
    v_mfma_f32_16x16x32_bf16 v[100:103], v[20:23], a[100:103], v[100:103]
    ds_read_b64_tr_b16 v[20:21], v2 offset:20480
    s_waitcnt lgkmcnt(3)
    v_mfma_f32_16x16x32_bf16 v[72:75], v[24:27], a[96:99], v[72:75]
    ds_read_b64_tr_b16 v[22:23], v2 offset:22528
    v_mfma_f32_16x16x32_bf16 v[104:107], v[24:27], a[100:103], v[104:107]
    ds_read_b64_tr_b16 v[24:25], v3 offset:20480
    v_mfma_f32_16x16x32_bf16 v[76:79], v[28:31], a[96:99], v[76:79]
    ds_read_b64_tr_b16 v[26:27], v3 offset:22528
    v_mfma_f32_16x16x32_bf16 v[108:111], v[28:31], a[100:103], v[108:111]
    ds_read_b64_tr_b16 v[28:29], v4 offset:20480
    s_waitcnt lgkmcnt(3)
    v_mfma_f32_16x16x32_bf16 v[8:11], v[16:19], a[96:99], v[8:11]
    ds_read_b64_tr_b16 v[30:31], v4 offset:22528
    v_mfma_f32_16x16x32_bf16 v[12:15], v[16:19], a[100:103], v[12:15]
    ds_read_b64_tr_b16 v[16:17], v5 offset:20480
    v_mfma_f32_16x16x32_bf16 v[48:51], v[20:23], a[104:107], v[48:51]
    ds_read_b64_tr_b16 v[18:19], v5 offset:22528
    v_mfma_f32_16x16x32_bf16 v[80:83], v[20:23], a[108:111], v[80:83]
    ds_read_b64_tr_b16 v[20:21], v2 offset:28672
    s_waitcnt lgkmcnt(3)
    v_mfma_f32_16x16x32_bf16 v[52:55], v[24:27], a[104:107], v[52:55]
    ds_read_b64_tr_b16 v[22:23], v2 offset:30720
    v_mfma_f32_16x16x32_bf16 v[84:87], v[24:27], a[108:111], v[84:87]
    ds_read_b64_tr_b16 v[24:25], v3 offset:28672
    v_mfma_f32_16x16x32_bf16 v[56:59], v[28:31], a[104:107], v[56:59]
    ds_read_b64_tr_b16 v[26:27], v3 offset:30720
    v_mfma_f32_16x16x32_bf16 v[88:91], v[28:31], a[108:111], v[88:91]
    ds_read_b64_tr_b16 v[28:29], v4 offset:28672
    s_waitcnt lgkmcnt(3)
    v_mfma_f32_16x16x32_bf16 v[60:63], v[16:19], a[104:107], v[60:63]
    ds_read_b64_tr_b16 v[30:31], v4 offset:30720
    v_mfma_f32_16x16x32_bf16 v[92:95], v[16:19], a[108:111], v[92:95]
    ds_read_b64_tr_b16 v[16:17], v5 offset:28672
    v_mfma_f32_16x16x32_bf16 v[64:67], v[20:23], a[104:107], v[64:67]
    ds_read_b64_tr_b16 v[18:19], v5 offset:30720
    v_mfma_f32_16x16x32_bf16 v[96:99], v[20:23], a[108:111], v[96:99]
    ds_read_b64_tr_b16 v[20:21], v7 offset:21504
    s_waitcnt lgkmcnt(3)
    v_mfma_f32_16x16x32_bf16 v[68:71], v[24:27], a[104:107], v[68:71]
    ds_read_b64_tr_b16 v[22:23], v7 offset:22016
    v_add_u32 v2, 0xfffe0000, v2
    v_mfma_f32_16x16x32_bf16 v[100:103], v[24:27], a[108:111], v[100:103]
    s_barrier
    ds_read_b64_tr_b16 v[24:25], v2 offset:32768
    v_mfma_f32_16x16x32_bf16 v[72:75], v[28:31], a[104:107], v[72:75]
    ds_read_b64_tr_b16 v[26:27], v2 offset:34816
    v_add_u32 v3, 0xfffe0000, v3
    v_mfma_f32_16x16x32_bf16 v[104:107], v[28:31], a[108:111], v[104:107]
    ds_read_b64_tr_b16 v[28:29], v3 offset:32768
    s_waitcnt lgkmcnt(3)
    v_mfma_f32_16x16x32_bf16 v[76:79], v[16:19], a[104:107], v[76:79]
    ds_read_b64_tr_b16 v[30:31], v3 offset:34816
    v_add_u32 v4, 0xfffe0000, v4
    v_mfma_f32_16x16x32_bf16 v[108:111], v[16:19], a[108:111], v[108:111]
    ds_read_b64_tr_b16 v[16:17], v4 offset:32768
    v_mfma_f32_16x16x32_bf16 v[8:11], v[20:23], a[104:107], v[8:11]
    ds_read_b64_tr_b16 v[18:19], v4 offset:34816
    v_add_u32 v5, 0xfffe0000, v5
    v_mfma_f32_16x16x32_bf16 v[12:15], v[20:23], a[108:111], v[12:15]
    ds_read_b64_tr_b16 v[20:21], v5 offset:32768
    s_waitcnt lgkmcnt(3)
    v_mfma_f32_16x16x32_bf16 v[48:51], v[24:27], a[112:115], v[48:51]
    ds_read_b64_tr_b16 v[22:23], v5 offset:34816
    v_mfma_f32_16x16x32_bf16 v[80:83], v[24:27], a[116:119], v[80:83]
    ds_read_b64_tr_b16 v[24:25], v2 offset:40960
    v_mfma_f32_16x16x32_bf16 v[52:55], v[28:31], a[112:115], v[52:55]
    ds_read_b64_tr_b16 v[26:27], v2 offset:43008
    v_mov_b32 v32, s64
    v_mfma_f32_16x16x32_bf16 v[84:87], v[28:31], a[116:119], v[84:87]
    ds_read_b64_tr_b16 v[28:29], v3 offset:40960
    s_waitcnt lgkmcnt(3)
    v_mfma_f32_16x16x32_bf16 v[56:59], v[16:19], a[112:115], v[56:59]
    ds_read_b64_tr_b16 v[30:31], v3 offset:43008
    v_lshlrev_b32 v33, 12, v0
    v_mfma_f32_16x16x32_bf16 v[88:91], v[16:19], a[116:119], v[88:91]
    ds_read_b64_tr_b16 v[16:17], v4 offset:40960
    v_mfma_f32_16x16x32_bf16 v[60:63], v[20:23], a[112:115], v[60:63]
    ds_read_b64_tr_b16 v[18:19], v4 offset:43008
    v_lshlrev_b32 v34, 3, v0
    v_mfma_f32_16x16x32_bf16 v[92:95], v[20:23], a[116:119], v[92:95]
    ds_read_b64_tr_b16 v[20:21], v5 offset:40960
    s_waitcnt lgkmcnt(3)
    v_mfma_f32_16x16x32_bf16 v[64:67], v[24:27], a[112:115], v[64:67]
    ds_read_b64_tr_b16 v[22:23], v5 offset:43008
    v_mfma_f32_16x16x32_bf16 v[96:99], v[24:27], a[116:119], v[96:99]
    ds_read_b64_tr_b16 v[24:25], v7 offset:22528
    v_mfma_f32_16x16x32_bf16 v[68:71], v[28:31], a[112:115], v[68:71]
    ds_read_b64_tr_b16 v[26:27], v7 offset:23040
    v_mfma_f32_16x16x32_bf16 v[100:103], v[28:31], a[116:119], v[100:103]
    ds_read_b64_tr_b16 v[28:29], v2 offset:36864
    s_waitcnt lgkmcnt(3)
    v_mfma_f32_16x16x32_bf16 v[72:75], v[16:19], a[112:115], v[72:75]
    ds_read_b64_tr_b16 v[30:31], v2 offset:38912
    v_mfma_f32_16x16x32_bf16 v[104:107], v[16:19], a[116:119], v[104:107]
    ds_read_b64_tr_b16 v[16:17], v3 offset:36864
    v_mfma_f32_16x16x32_bf16 v[76:79], v[20:23], a[112:115], v[76:79]
    ds_read_b64_tr_b16 v[18:19], v3 offset:38912
    v_mfma_f32_16x16x32_bf16 v[108:111], v[20:23], a[116:119], v[108:111]
    ds_read_b64_tr_b16 v[20:21], v4 offset:36864
    s_waitcnt lgkmcnt(3)
    v_mfma_f32_16x16x32_bf16 v[8:11], v[24:27], a[112:115], v[8:11]
    ds_read_b64_tr_b16 v[22:23], v4 offset:38912
    v_mfma_f32_16x16x32_bf16 v[12:15], v[24:27], a[116:119], v[12:15]
    ds_read_b64_tr_b16 v[24:25], v5 offset:36864
    v_mfma_f32_16x16x32_bf16 v[48:51], v[28:31], a[120:123], v[48:51]
    ds_read_b64_tr_b16 v[26:27], v5 offset:38912
    v_mfma_f32_16x16x32_bf16 v[80:83], v[28:31], a[124:127], v[80:83]
    ds_read_b64_tr_b16 v[28:29], v2 offset:45056
    s_waitcnt lgkmcnt(3)
    v_mfma_f32_16x16x32_bf16 v[52:55], v[16:19], a[120:123], v[52:55]
    ds_read_b64_tr_b16 v[30:31], v2 offset:47104
    v_mfma_f32_16x16x32_bf16 v[84:87], v[16:19], a[124:127], v[84:87]
    ds_read_b64_tr_b16 v[16:17], v3 offset:45056
    v_mfma_f32_16x16x32_bf16 v[56:59], v[20:23], a[120:123], v[56:59]
    ds_read_b64_tr_b16 v[18:19], v3 offset:47104
    v_mfma_f32_16x16x32_bf16 v[88:91], v[20:23], a[124:127], v[88:91]
    ds_read_b64_tr_b16 v[20:21], v4 offset:45056
    s_waitcnt lgkmcnt(3)
    v_mfma_f32_16x16x32_bf16 v[60:63], v[24:27], a[120:123], v[60:63]
    ds_read_b64_tr_b16 v[22:23], v4 offset:47104
    v_mfma_f32_16x16x32_bf16 v[92:95], v[24:27], a[124:127], v[92:95]
    ds_read_b64_tr_b16 v[24:25], v5 offset:45056
    v_mfma_f32_16x16x32_bf16 v[64:67], v[28:31], a[120:123], v[64:67]
    ds_read_b64_tr_b16 v[26:27], v5 offset:47104
    v_mfma_f32_16x16x32_bf16 v[96:99], v[28:31], a[124:127], v[96:99]
    ds_read_b64_tr_b16 v[28:29], v7 offset:23552
    s_waitcnt lgkmcnt(3)
    v_mfma_f32_16x16x32_bf16 v[68:71], v[16:19], a[120:123], v[68:71]
    ds_read_b64_tr_b16 v[30:31], v7 offset:24064
    v_add_u32 v2, 0x10000, v2
    v_mfma_f32_16x16x32_bf16 v[100:103], v[16:19], a[124:127], v[100:103]
    s_barrier
    ds_read_b64_tr_b16 v[16:17], v2 offset:32768
    v_mfma_f32_16x16x32_bf16 v[72:75], v[20:23], a[120:123], v[72:75]
    ds_read_b64_tr_b16 v[18:19], v2 offset:34816
    v_add_u32 v3, 0x10000, v3
    v_mfma_f32_16x16x32_bf16 v[104:107], v[20:23], a[124:127], v[104:107]
    ds_read_b64_tr_b16 v[20:21], v3 offset:32768
    s_waitcnt lgkmcnt(3)
    v_mfma_f32_16x16x32_bf16 v[76:79], v[24:27], a[120:123], v[76:79]
    ds_read_b64_tr_b16 v[22:23], v3 offset:34816
    v_add_u32 v4, 0x10000, v4
    v_mfma_f32_16x16x32_bf16 v[108:111], v[24:27], a[124:127], v[108:111]
    ds_read_b64_tr_b16 v[24:25], v4 offset:32768
    v_mfma_f32_16x16x32_bf16 v[8:11], v[28:31], a[120:123], v[8:11]
    ds_read_b64_tr_b16 v[26:27], v4 offset:34816
    v_add_u32 v5, 0x10000, v5
    v_mfma_f32_16x16x32_bf16 v[12:15], v[28:31], a[124:127], v[12:15]
    ds_read_b64_tr_b16 v[28:29], v5 offset:32768
    s_waitcnt lgkmcnt(3)
    v_mfma_f32_16x16x32_bf16 v[48:51], v[16:19], a[128:131], v[48:51]
    ds_read_b64_tr_b16 v[30:31], v5 offset:34816
    v_mfma_f32_16x16x32_bf16 v[80:83], v[16:19], a[132:135], v[80:83]
    ds_read_b64_tr_b16 v[16:17], v2 offset:40960
    v_mfma_f32_16x16x32_bf16 v[52:55], v[20:23], a[128:131], v[52:55]
    ds_read_b64_tr_b16 v[18:19], v2 offset:43008
    v_mfma_f32_16x16x32_bf16 v[84:87], v[20:23], a[132:135], v[84:87]
    ds_read_b64_tr_b16 v[20:21], v3 offset:40960
    s_waitcnt lgkmcnt(3)
    v_mfma_f32_16x16x32_bf16 v[56:59], v[24:27], a[128:131], v[56:59]
    ds_read_b64_tr_b16 v[22:23], v3 offset:43008
    v_mfma_f32_16x16x32_bf16 v[88:91], v[24:27], a[132:135], v[88:91]
    ds_read_b64_tr_b16 v[24:25], v4 offset:40960
    v_mfma_f32_16x16x32_bf16 v[60:63], v[28:31], a[128:131], v[60:63]
    ds_read_b64_tr_b16 v[26:27], v4 offset:43008
    v_mfma_f32_16x16x32_bf16 v[92:95], v[28:31], a[132:135], v[92:95]
    ds_read_b64_tr_b16 v[28:29], v5 offset:40960
    s_waitcnt lgkmcnt(3)
    v_mfma_f32_16x16x32_bf16 v[64:67], v[16:19], a[128:131], v[64:67]
    ds_read_b64_tr_b16 v[30:31], v5 offset:43008
    v_mfma_f32_16x16x32_bf16 v[96:99], v[16:19], a[132:135], v[96:99]
    ds_read_b64_tr_b16 v[16:17], v7 offset:24576
    v_mfma_f32_16x16x32_bf16 v[68:71], v[20:23], a[128:131], v[68:71]
    ds_read_b64_tr_b16 v[18:19], v7 offset:25088
    v_mfma_f32_16x16x32_bf16 v[100:103], v[20:23], a[132:135], v[100:103]
    ds_read_b64_tr_b16 v[20:21], v2 offset:36864
    s_waitcnt lgkmcnt(3)
    v_mfma_f32_16x16x32_bf16 v[72:75], v[24:27], a[128:131], v[72:75]
    ds_read_b64_tr_b16 v[22:23], v2 offset:38912
    v_mfma_f32_16x16x32_bf16 v[104:107], v[24:27], a[132:135], v[104:107]
    ds_read_b64_tr_b16 v[24:25], v3 offset:36864
    v_mfma_f32_16x16x32_bf16 v[76:79], v[28:31], a[128:131], v[76:79]
    ds_read_b64_tr_b16 v[26:27], v3 offset:38912
    v_mfma_f32_16x16x32_bf16 v[108:111], v[28:31], a[132:135], v[108:111]
    ds_read_b64_tr_b16 v[28:29], v4 offset:36864
    s_waitcnt lgkmcnt(3)
    v_mfma_f32_16x16x32_bf16 v[8:11], v[16:19], a[128:131], v[8:11]
    ds_read_b64_tr_b16 v[30:31], v4 offset:38912
    v_mfma_f32_16x16x32_bf16 v[12:15], v[16:19], a[132:135], v[12:15]
    ds_read_b64_tr_b16 v[16:17], v5 offset:36864
    v_mfma_f32_16x16x32_bf16 v[48:51], v[20:23], a[136:139], v[48:51]
    ds_read_b64_tr_b16 v[18:19], v5 offset:38912
    v_mfma_f32_16x16x32_bf16 v[80:83], v[20:23], a[140:143], v[80:83]
    ds_read_b64_tr_b16 v[20:21], v2 offset:45056
    s_waitcnt lgkmcnt(3)
    v_mfma_f32_16x16x32_bf16 v[52:55], v[24:27], a[136:139], v[52:55]
    ds_read_b64_tr_b16 v[22:23], v2 offset:47104
    v_mfma_f32_16x16x32_bf16 v[84:87], v[24:27], a[140:143], v[84:87]
    ds_read_b64_tr_b16 v[24:25], v3 offset:45056
    v_mfma_f32_16x16x32_bf16 v[56:59], v[28:31], a[136:139], v[56:59]
    ds_read_b64_tr_b16 v[26:27], v3 offset:47104
    v_mfma_f32_16x16x32_bf16 v[88:91], v[28:31], a[140:143], v[88:91]
    ds_read_b64_tr_b16 v[28:29], v4 offset:45056
    s_waitcnt lgkmcnt(3)
    v_mfma_f32_16x16x32_bf16 v[60:63], v[16:19], a[136:139], v[60:63]
    ds_read_b64_tr_b16 v[30:31], v4 offset:47104
    v_add_u32 v3, 0xffff0000, v3
    v_mfma_f32_16x16x32_bf16 v[92:95], v[16:19], a[140:143], v[92:95]
    ds_read_b64_tr_b16 v[16:17], v5 offset:45056
    v_mfma_f32_16x16x32_bf16 v[64:67], v[20:23], a[136:139], v[64:67]
    ds_read_b64_tr_b16 v[18:19], v5 offset:47104
    v_add_u32 v2, 0xffff0000, v2
    v_mfma_f32_16x16x32_bf16 v[96:99], v[20:23], a[140:143], v[96:99]
    ds_read_b64_tr_b16 v[20:21], v7 offset:25600
    s_waitcnt lgkmcnt(3)
    v_mfma_f32_16x16x32_bf16 v[68:71], v[24:27], a[136:139], v[68:71]
    ds_read_b64_tr_b16 v[22:23], v7 offset:26112
    v_add_u32 v6, 0x10000, v6
    v_mfma_f32_16x16x32_bf16 v[100:103], v[24:27], a[140:143], v[100:103]
    s_barrier
    ds_read_b128 a[40:43], v6 offset:0
    ds_read_b128 a[44:47], v6 offset:1024
    ds_read_b64_tr_b16 v[24:25], v2 offset:49152
    v_mfma_f32_16x16x32_bf16 v[72:75], v[28:31], a[136:139], v[72:75]
    ds_read_b64_tr_b16 v[26:27], v2 offset:51200
    ds_read_b128 a[48:51], v6 offset:2048
    v_mfma_f32_16x16x32_bf16 v[104:107], v[28:31], a[140:143], v[104:107]
    ds_read_b64_tr_b16 v[28:29], v3 offset:49152
    s_waitcnt lgkmcnt(6)
    v_mfma_f32_16x16x32_bf16 v[76:79], v[16:19], a[136:139], v[76:79]
    ds_read_b64_tr_b16 v[30:31], v3 offset:51200
    ds_read_b128 a[52:55], v6 offset:3072
    v_mfma_f32_16x16x32_bf16 v[108:111], v[16:19], a[140:143], v[108:111]
    ds_read_b64_tr_b16 v[16:17], v7 offset:26624
    v_mfma_f32_16x16x32_bf16 v[8:11], v[20:23], a[136:139], v[8:11]
    ds_read_b64_tr_b16 v[18:19], v7 offset:27136
    ds_read_b128 a[56:59], v6 offset:49152
    v_mfma_f32_16x16x32_bf16 v[12:15], v[20:23], a[140:143], v[12:15]
    ds_read_b64_tr_b16 v[20:21], v2 offset:53248
    s_waitcnt lgkmcnt(5)
    v_mfma_f32_16x16x32_bf16 v[48:51], v[24:27], a[40:43], v[48:51]
    ds_read_b64_tr_b16 v[22:23], v2 offset:55296
    ds_read_b128 a[60:63], v6 offset:50176
    v_mfma_f32_16x16x32_bf16 v[80:83], v[24:27], a[44:47], v[80:83]
    ds_read_b64_tr_b16 v[24:25], v3 offset:53248
    v_mfma_f32_16x16x32_bf16 v[52:55], v[28:31], a[40:43], v[52:55]
    ds_read_b64_tr_b16 v[26:27], v3 offset:55296
    ds_read_b128 a[64:67], v6 offset:51200
    v_mfma_f32_16x16x32_bf16 v[84:87], v[28:31], a[44:47], v[84:87]
    ds_read_b64_tr_b16 v[28:29], v7 offset:27648
    s_waitcnt lgkmcnt(5)
    v_mfma_f32_16x16x32_bf16 v[8:11], v[16:19], a[40:43], v[8:11]
    ds_read_b64_tr_b16 v[30:31], v7 offset:28160
    ds_read_b128 a[68:71], v6 offset:52224
    v_mfma_f32_16x16x32_bf16 v[12:15], v[16:19], a[44:47], v[12:15]
    ds_read_b64_tr_b16 v[16:17], v2 offset:57344
    v_mfma_f32_16x16x32_bf16 v[48:51], v[20:23], a[48:51], v[48:51]
    ds_read_b64_tr_b16 v[18:19], v2 offset:59392
    v_mfma_f32_16x16x32_bf16 v[80:83], v[20:23], a[52:55], v[80:83]
    ds_read_b64_tr_b16 v[20:21], v3 offset:57344
    s_waitcnt lgkmcnt(4)
    v_mfma_f32_16x16x32_bf16 v[52:55], v[24:27], a[48:51], v[52:55]
    ds_read_b64_tr_b16 v[22:23], v3 offset:59392
    v_mfma_f32_16x16x32_bf16 v[84:87], v[24:27], a[52:55], v[84:87]
    ds_read_b64_tr_b16 v[24:25], v7 offset:28672
    v_mfma_f32_16x16x32_bf16 v[8:11], v[28:31], a[48:51], v[8:11]
    ds_read_b64_tr_b16 v[26:27], v7 offset:29184
    v_mfma_f32_16x16x32_bf16 v[12:15], v[28:31], a[52:55], v[12:15]
    ds_read_b64_tr_b16 v[28:29], v2 offset:61440
    s_waitcnt lgkmcnt(3)
    v_mfma_f32_16x16x32_bf16 v[48:51], v[16:19], a[56:59], v[48:51]
    ds_read_b64_tr_b16 v[30:31], v2 offset:63488
    v_mfma_f32_16x16x32_bf16 v[80:83], v[16:19], a[60:63], v[80:83]
    ds_read_b64_tr_b16 v[16:17], v3 offset:61440
    v_mfma_f32_16x16x32_bf16 v[52:55], v[20:23], a[56:59], v[52:55]
    ds_read_b64_tr_b16 v[18:19], v3 offset:63488
    v_add_u32 v2, 0x10000, v2
    v_mfma_f32_16x16x32_bf16 v[84:87], v[20:23], a[60:63], v[84:87]
    ds_read_b64_tr_b16 v[20:21], v7 offset:29696
    s_waitcnt lgkmcnt(3)
    v_mfma_f32_16x16x32_bf16 v[8:11], v[24:27], a[56:59], v[8:11]
    ds_read_b64_tr_b16 v[22:23], v7 offset:30208
    v_add_u32 v6, 0xffff0000, v6
    v_mfma_f32_16x16x32_bf16 v[12:15], v[24:27], a[60:63], v[12:15]
    s_barrier
    ds_read_b128 a[72:75], v6 offset:0
    ds_read_b128 a[76:79], v6 offset:1024
    ds_read_b64_tr_b16 v[24:25], v2 offset:16384
    v_mfma_f32_16x16x32_bf16 v[48:51], v[28:31], a[64:67], v[48:51]
    ds_read_b64_tr_b16 v[26:27], v2 offset:18432
    ds_read_b128 a[80:83], v6 offset:2048
    v_mfma_f32_16x16x32_bf16 v[80:83], v[28:31], a[68:71], v[80:83]
    v_add_u32 v3, 0x10000, v3
    ds_read_b64_tr_b16 v[28:29], v3 offset:16384
    s_waitcnt lgkmcnt(6)
    v_mfma_f32_16x16x32_bf16 v[52:55], v[16:19], a[64:67], v[52:55]
    ds_read_b64_tr_b16 v[30:31], v3 offset:18432
    ds_read_b128 a[84:87], v6 offset:3072
    v_mfma_f32_16x16x32_bf16 v[84:87], v[16:19], a[68:71], v[84:87]
    ds_read_b64_tr_b16 v[16:17], v7 offset:30720
    v_mfma_f32_16x16x32_bf16 v[8:11], v[20:23], a[64:67], v[8:11]
    ds_read_b64_tr_b16 v[18:19], v7 offset:31232
    v_add_u32 v6, 0x20000, v6
    ds_read_b64 a[34:35], v6 offset:0
    v_mfma_f32_16x16x32_bf16 v[12:15], v[20:23], a[68:71], v[12:15]
    ds_read_b64_tr_b16 v[20:21], v2 offset:20480
    s_waitcnt lgkmcnt(5)
    v_mfma_f32_16x16x32_bf16 v[48:51], v[24:27], a[72:75], v[48:51]
    ds_read_b64_tr_b16 v[22:23], v2 offset:22528
    ds_read_b64 a[38:39], v6 offset:8
    v_mfma_f32_16x16x32_bf16 v[80:83], v[24:27], a[76:79], v[80:83]
    ds_read_b64_tr_b16 v[24:25], v3 offset:20480
    v_mfma_f32_16x16x32_bf16 v[52:55], v[28:31], a[72:75], v[52:55]
    ds_read_b64_tr_b16 v[26:27], v3 offset:22528
    ds_read_b64 a[88:89], v6 offset:1024
    v_mfma_f32_16x16x32_bf16 v[84:87], v[28:31], a[76:79], v[84:87]
    ds_read_b64_tr_b16 v[28:29], v7 offset:31744
    s_waitcnt lgkmcnt(5)
    v_mfma_f32_16x16x32_bf16 v[8:11], v[16:19], a[72:75], v[8:11]
    ds_read_b64_tr_b16 v[30:31], v7 offset:32256
    ds_read_b64 a[90:91], v6 offset:2048
    v_mfma_f32_16x16x32_bf16 v[12:15], v[16:19], a[76:79], v[12:15]
    ds_read_b64_tr_b16 v[16:17], v2 offset:24576
    v_mfma_f32_16x16x32_bf16 v[48:51], v[20:23], a[80:83], v[48:51]
    ds_read_b64_tr_b16 v[18:19], v2 offset:26624
    ds_read_b64 a[92:93], v6 offset:1032
    v_mfma_f32_16x16x32_bf16 v[80:83], v[20:23], a[84:87], v[80:83]
    ds_read_b64_tr_b16 v[20:21], v3 offset:24576
    s_waitcnt lgkmcnt(5)
    v_mfma_f32_16x16x32_bf16 v[52:55], v[24:27], a[80:83], v[52:55]
    ds_read_b64_tr_b16 v[22:23], v3 offset:26624
    ds_read_b64 a[94:95], v6 offset:2056
    v_mfma_f32_16x16x32_bf16 v[84:87], v[24:27], a[84:87], v[84:87]
    v_add_u32 v7, 0x20000, v7
    ds_read_b64_tr_b16 v[24:25], v7 offset:3072
    v_mfma_f32_16x16x32_bf16 v[8:11], v[28:31], a[80:83], v[8:11]
    ds_read_b64_tr_b16 v[26:27], v7 offset:3584
    v_mfma_f32_16x16x32_bf16 v[12:15], v[28:31], a[84:87], v[12:15]
    ds_read_b64_tr_b16 v[28:29], v2 offset:28672
    s_waitcnt lgkmcnt(4)
    v_mfma_f32_16x16x32_bf16 v[48:51], v[16:19], a[32:35], v[48:51]
    ds_read_b64_tr_b16 v[30:31], v2 offset:30720
    v_mfma_f32_16x16x32_bf16 v[80:83], v[16:19], a[36:39], v[80:83]
    ds_read_b64_tr_b16 v[16:17], v3 offset:28672
    v_mfma_f32_16x16x32_bf16 v[52:55], v[20:23], a[32:35], v[52:55]
    ds_read_b64_tr_b16 v[18:19], v3 offset:30720
    v_mfma_f32_16x16x32_bf16 v[84:87], v[20:23], a[36:39], v[84:87]
    ds_read_b64_tr_b16 v[20:21], v7 offset:7168
    s_waitcnt lgkmcnt(3)
    v_mfma_f32_16x16x32_bf16 v[8:11], v[24:27], a[32:35], v[8:11]
    ds_read_b64_tr_b16 v[22:23], v7 offset:7680
    v_add_u32 v4, 0xffff0000, v4
    v_mfma_f32_16x16x32_bf16 v[12:15], v[24:27], a[36:39], v[12:15]
    s_barrier
    ds_read_b64_tr_b16 v[24:25], v4 offset:49152
    v_mfma_f32_16x16x32_bf16 v[48:51], v[28:31], a[88:91], v[48:51]
    ds_read_b64_tr_b16 v[26:27], v4 offset:51200
    v_add_u32 v5, 0xffff0000, v5
    v_mfma_f32_16x16x32_bf16 v[80:83], v[28:31], a[92:95], v[80:83]
    ds_read_b64_tr_b16 v[28:29], v5 offset:49152
    s_waitcnt lgkmcnt(3)
    v_mfma_f32_16x16x32_bf16 v[52:55], v[16:19], a[88:91], v[52:55]
    ds_read_b64_tr_b16 v[30:31], v5 offset:51200
    v_mfma_f32_16x16x32_bf16 v[84:87], v[16:19], a[92:95], v[84:87]
    ds_read_b64_tr_b16 v[16:17], v4 offset:53248
    v_mfma_f32_16x16x32_bf16 v[8:11], v[20:23], a[88:91], v[8:11]
    ds_read_b64_tr_b16 v[18:19], v4 offset:55296
    v_add_u32 v3, 0x10000, v3
    v_mfma_f32_16x16x32_bf16 v[12:15], v[20:23], a[92:95], v[12:15]
    ds_read_b64_tr_b16 v[20:21], v5 offset:53248
    s_waitcnt lgkmcnt(3)
    v_mfma_f32_16x16x32_bf16 v[56:59], v[24:27], a[40:43], v[56:59]
    ds_read_b64_tr_b16 v[22:23], v5 offset:55296
    v_add_u32 v2, 0x10000, v2
    v_mfma_f32_16x16x32_bf16 v[88:91], v[24:27], a[44:47], v[88:91]
    ds_read_b64_tr_b16 v[24:25], v4 offset:57344
    v_mfma_f32_16x16x32_bf16 v[60:63], v[28:31], a[40:43], v[60:63]
    ds_read_b64_tr_b16 v[26:27], v4 offset:59392
    v_cvt_pk_bf16_f32 v48, v48, v49
    v_mfma_f32_16x16x32_bf16 v[92:95], v[28:31], a[44:47], v[92:95]
    ds_read_b64_tr_b16 v[28:29], v5 offset:57344
    s_waitcnt lgkmcnt(3)
    v_mfma_f32_16x16x32_bf16 v[56:59], v[16:19], a[48:51], v[56:59]
    ds_read_b64_tr_b16 v[30:31], v5 offset:59392
    v_cvt_pk_bf16_f32 v49, v50, v51
    v_mfma_f32_16x16x32_bf16 v[88:91], v[16:19], a[52:55], v[88:91]
    ds_read_b64_tr_b16 v[16:17], v4 offset:61440
    v_mfma_f32_16x16x32_bf16 v[60:63], v[20:23], a[48:51], v[60:63]
    ds_read_b64_tr_b16 v[18:19], v4 offset:63488
    v_cvt_pk_bf16_f32 v50, v52, v53
    v_mfma_f32_16x16x32_bf16 v[92:95], v[20:23], a[52:55], v[92:95]
    ds_read_b64_tr_b16 v[20:21], v5 offset:61440
    s_waitcnt lgkmcnt(3)
    v_mfma_f32_16x16x32_bf16 v[56:59], v[24:27], a[56:59], v[56:59]
    ds_read_b64_tr_b16 v[22:23], v5 offset:63488
    v_cvt_pk_bf16_f32 v51, v54, v55
    v_mfma_f32_16x16x32_bf16 v[88:91], v[24:27], a[60:63], v[88:91]
    v_add_u32 v4, 0x10000, v4
    ds_read_b64_tr_b16 v[24:25], v4 offset:16384
    v_mfma_f32_16x16x32_bf16 v[60:63], v[28:31], a[56:59], v[60:63]
    ds_read_b64_tr_b16 v[26:27], v4 offset:18432
    buffer_store_dwordx4 v[48:51], v1, s[24:27], s17 offen sc1
    s_add_u32 s17, s17, 2097152
    v_mfma_f32_16x16x32_bf16 v[92:95], v[28:31], a[60:63], v[92:95]
    v_add_u32 v5, 0x10000, v5
    ds_read_b64_tr_b16 v[28:29], v5 offset:16384
    s_waitcnt lgkmcnt(3)
    v_mfma_f32_16x16x32_bf16 v[56:59], v[16:19], a[64:67], v[56:59]
    ds_read_b64_tr_b16 v[30:31], v5 offset:18432
    v_cvt_pk_bf16_f32 v80, v80, v81
    v_mfma_f32_16x16x32_bf16 v[88:91], v[16:19], a[68:71], v[88:91]
    ds_read_b64_tr_b16 v[16:17], v4 offset:20480
    v_mfma_f32_16x16x32_bf16 v[60:63], v[20:23], a[64:67], v[60:63]
    ds_read_b64_tr_b16 v[18:19], v4 offset:22528
    v_cvt_pk_bf16_f32 v81, v82, v83
    v_mfma_f32_16x16x32_bf16 v[92:95], v[20:23], a[68:71], v[92:95]
    ds_read_b64_tr_b16 v[20:21], v5 offset:20480
    s_waitcnt lgkmcnt(3)
    v_mfma_f32_16x16x32_bf16 v[56:59], v[24:27], a[72:75], v[56:59]
    ds_read_b64_tr_b16 v[22:23], v5 offset:22528
    v_cvt_pk_bf16_f32 v82, v84, v85
    v_mfma_f32_16x16x32_bf16 v[88:91], v[24:27], a[76:79], v[88:91]
    ds_read_b64_tr_b16 v[24:25], v4 offset:24576
    v_mfma_f32_16x16x32_bf16 v[60:63], v[28:31], a[72:75], v[60:63]
    ds_read_b64_tr_b16 v[26:27], v4 offset:26624
    v_cvt_pk_bf16_f32 v83, v86, v87
    v_mfma_f32_16x16x32_bf16 v[92:95], v[28:31], a[76:79], v[92:95]
    ds_read_b64_tr_b16 v[28:29], v5 offset:24576
    s_waitcnt lgkmcnt(3)
    v_mfma_f32_16x16x32_bf16 v[56:59], v[16:19], a[80:83], v[56:59]
    ds_read_b64_tr_b16 v[30:31], v5 offset:26624
    buffer_store_dwordx4 v[80:83], v1, s[24:27], s18 offen sc1
    s_add_u32 s18, s18, 2097152
    v_mfma_f32_16x16x32_bf16 v[88:91], v[16:19], a[84:87], v[88:91]
    ds_read_b64_tr_b16 v[16:17], v4 offset:28672
    v_mfma_f32_16x16x32_bf16 v[60:63], v[20:23], a[80:83], v[60:63]
    ds_read_b64_tr_b16 v[18:19], v4 offset:30720
    v_cvt_pk_bf16_f32 v8, v8, v9
    v_mfma_f32_16x16x32_bf16 v[92:95], v[20:23], a[84:87], v[92:95]
    ds_read_b64_tr_b16 v[20:21], v5 offset:28672
    s_waitcnt lgkmcnt(3)
    v_mfma_f32_16x16x32_bf16 v[56:59], v[24:27], a[32:35], v[56:59]
    ds_read_b64_tr_b16 v[22:23], v5 offset:30720
    v_cvt_pk_bf16_f32 v9, v10, v11
    v_mfma_f32_16x16x32_bf16 v[88:91], v[24:27], a[36:39], v[88:91]
    s_barrier
    ds_read_b64_tr_b16 v[24:25], v2 offset:16384
    v_mfma_f32_16x16x32_bf16 v[60:63], v[28:31], a[32:35], v[60:63]
    ds_read_b64_tr_b16 v[26:27], v2 offset:18432
    buffer_store_dwordx2 v[8:9], v34, s[24:27], s19 offen sc1
    v_mfma_f32_16x16x32_bf16 v[92:95], v[28:31], a[36:39], v[92:95]
    ds_read_b64_tr_b16 v[28:29], v3 offset:16384
    s_waitcnt lgkmcnt(3)
    v_mfma_f32_16x16x32_bf16 v[56:59], v[16:19], a[88:91], v[56:59]
    ds_read_b64_tr_b16 v[30:31], v3 offset:18432
    v_cvt_pk_bf16_f32 v12, v12, v13
    v_mfma_f32_16x16x32_bf16 v[88:91], v[16:19], a[92:95], v[88:91]
    ds_read_b64_tr_b16 v[16:17], v2 offset:20480
    v_mfma_f32_16x16x32_bf16 v[60:63], v[20:23], a[88:91], v[60:63]
    ds_read_b64_tr_b16 v[18:19], v2 offset:22528
    v_cvt_pk_bf16_f32 v13, v14, v15
    v_mfma_f32_16x16x32_bf16 v[92:95], v[20:23], a[92:95], v[92:95]
    ds_read_b64_tr_b16 v[20:21], v3 offset:20480
    s_waitcnt lgkmcnt(3)
    v_mfma_f32_16x16x32_bf16 v[64:67], v[24:27], a[40:43], v[64:67]
    ds_read_b64_tr_b16 v[22:23], v3 offset:22528
    buffer_store_dwordx2 v[12:13], v34, s[24:27], s20 offen sc1
    v_mfma_f32_16x16x32_bf16 v[96:99], v[24:27], a[44:47], v[96:99]
    ds_read_b64_tr_b16 v[24:25], v2 offset:24576
    v_mfma_f32_16x16x32_bf16 v[68:71], v[28:31], a[40:43], v[68:71]
    ds_read_b64_tr_b16 v[26:27], v2 offset:26624
    v_mfma_f32_16x16x32_bf16 v[100:103], v[28:31], a[44:47], v[100:103]
    ds_read_b64_tr_b16 v[28:29], v3 offset:24576
    s_waitcnt lgkmcnt(3)
    v_mfma_f32_16x16x32_bf16 v[64:67], v[16:19], a[48:51], v[64:67]
    ds_read_b64_tr_b16 v[30:31], v3 offset:26624
    v_add_u32 v4, 0x10000, v4
    v_mfma_f32_16x16x32_bf16 v[96:99], v[16:19], a[52:55], v[96:99]
    ds_read_b64_tr_b16 v[16:17], v2 offset:28672
    v_mfma_f32_16x16x32_bf16 v[68:71], v[20:23], a[48:51], v[68:71]
    ds_read_b64_tr_b16 v[18:19], v2 offset:30720
    v_cvt_pk_bf16_f32 v56, v56, v57
    v_mfma_f32_16x16x32_bf16 v[100:103], v[20:23], a[52:55], v[100:103]
    ds_read_b64_tr_b16 v[20:21], v3 offset:28672
    s_waitcnt lgkmcnt(3)
    v_mfma_f32_16x16x32_bf16 v[64:67], v[24:27], a[56:59], v[64:67]
    s_branch L_skippad5
.p2align 12
L_pad5:
    s_setpc_b64 s[50:51]
L_skippad5:
    ds_read_b64_tr_b16 v[22:23], v3 offset:30720
    v_cvt_pk_bf16_f32 v57, v58, v59
    v_mfma_f32_16x16x32_bf16 v[96:99], v[24:27], a[60:63], v[96:99]
    v_add_u32 v2, 0xfffe0000, v2
    ds_read_b64_tr_b16 v[24:25], v2 offset:32768
    v_mfma_f32_16x16x32_bf16 v[68:71], v[28:31], a[56:59], v[68:71]
    ds_read_b64_tr_b16 v[26:27], v2 offset:34816
    v_cvt_pk_bf16_f32 v58, v60, v61
    v_mfma_f32_16x16x32_bf16 v[100:103], v[28:31], a[60:63], v[100:103]
    v_add_u32 v3, 0xfffe0000, v3
    ds_read_b64_tr_b16 v[28:29], v3 offset:32768
    s_waitcnt lgkmcnt(3)
    v_mfma_f32_16x16x32_bf16 v[64:67], v[16:19], a[64:67], v[64:67]
    ds_read_b64_tr_b16 v[30:31], v3 offset:34816
    v_cvt_pk_bf16_f32 v59, v62, v63
    v_mfma_f32_16x16x32_bf16 v[96:99], v[16:19], a[68:71], v[96:99]
    ds_read_b64_tr_b16 v[16:17], v2 offset:36864
    v_mfma_f32_16x16x32_bf16 v[68:71], v[20:23], a[64:67], v[68:71]
    ds_read_b64_tr_b16 v[18:19], v2 offset:38912
    buffer_store_dwordx4 v[56:59], v1, s[24:27], s17 offen sc1
    s_add_u32 s17, s17, 2097152
    v_mfma_f32_16x16x32_bf16 v[100:103], v[20:23], a[68:71], v[100:103]
    ds_read_b64_tr_b16 v[20:21], v3 offset:36864
    s_waitcnt lgkmcnt(3)
    v_mfma_f32_16x16x32_bf16 v[64:67], v[24:27], a[72:75], v[64:67]
    ds_read_b64_tr_b16 v[22:23], v3 offset:38912
    v_cvt_pk_bf16_f32 v88, v88, v89
    v_mfma_f32_16x16x32_bf16 v[96:99], v[24:27], a[76:79], v[96:99]
    ds_read_b64_tr_b16 v[24:25], v2 offset:40960
    v_mfma_f32_16x16x32_bf16 v[68:71], v[28:31], a[72:75], v[68:71]
    ds_read_b64_tr_b16 v[26:27], v2 offset:43008
    v_cvt_pk_bf16_f32 v89, v90, v91
    v_mfma_f32_16x16x32_bf16 v[100:103], v[28:31], a[76:79], v[100:103]
    ds_read_b64_tr_b16 v[28:29], v3 offset:40960
    s_waitcnt lgkmcnt(3)
    v_mfma_f32_16x16x32_bf16 v[64:67], v[16:19], a[80:83], v[64:67]
    ds_read_b64_tr_b16 v[30:31], v3 offset:43008
    v_cvt_pk_bf16_f32 v90, v92, v93
    v_mfma_f32_16x16x32_bf16 v[96:99], v[16:19], a[84:87], v[96:99]
    ds_read_b64_tr_b16 v[16:17], v2 offset:45056
    v_mfma_f32_16x16x32_bf16 v[68:71], v[20:23], a[80:83], v[68:71]
    ds_read_b64_tr_b16 v[18:19], v2 offset:47104
    v_cvt_pk_bf16_f32 v91, v94, v95
    v_mfma_f32_16x16x32_bf16 v[100:103], v[20:23], a[84:87], v[100:103]
    ds_read_b64_tr_b16 v[20:21], v3 offset:45056
    s_waitcnt lgkmcnt(3)
    v_mfma_f32_16x16x32_bf16 v[64:67], v[24:27], a[32:35], v[64:67]
    ds_read_b64_tr_b16 v[22:23], v3 offset:47104
    buffer_store_dwordx4 v[88:91], v1, s[24:27], s18 offen sc1
    s_add_u32 s18, s18, 2097152
    v_mfma_f32_16x16x32_bf16 v[96:99], v[24:27], a[36:39], v[96:99]
    ds_read_b64_tr_b16 v[24:25], v4 offset:16384
    v_mfma_f32_16x16x32_bf16 v[68:71], v[28:31], a[32:35], v[68:71]
    ds_read_b64_tr_b16 v[26:27], v4 offset:18432
    v_add_u32 v5, 0x10000, v5
    v_mfma_f32_16x16x32_bf16 v[100:103], v[28:31], a[36:39], v[100:103]
    ds_read_b64_tr_b16 v[28:29], v5 offset:16384
    s_waitcnt lgkmcnt(3)
    v_mfma_f32_16x16x32_bf16 v[64:67], v[16:19], a[88:91], v[64:67]
    ds_read_b64_tr_b16 v[30:31], v5 offset:18432
    v_mfma_f32_16x16x32_bf16 v[96:99], v[16:19], a[92:95], v[96:99]
    ds_read_b64_tr_b16 v[16:17], v4 offset:20480
    v_mfma_f32_16x16x32_bf16 v[68:71], v[20:23], a[88:91], v[68:71]
    ds_read_b64_tr_b16 v[18:19], v4 offset:22528
    v_mfma_f32_16x16x32_bf16 v[100:103], v[20:23], a[92:95], v[100:103]
    ds_read_b64_tr_b16 v[20:21], v5 offset:20480
    s_waitcnt lgkmcnt(3)
    v_mfma_f32_16x16x32_bf16 v[72:75], v[24:27], a[40:43], v[72:75]
    ds_read_b64_tr_b16 v[22:23], v5 offset:22528
    v_mfma_f32_16x16x32_bf16 v[104:107], v[24:27], a[44:47], v[104:107]
    ds_read_b64_tr_b16 v[24:25], v4 offset:24576
    v_mfma_f32_16x16x32_bf16 v[76:79], v[28:31], a[40:43], v[76:79]
    ds_read_b64_tr_b16 v[26:27], v4 offset:26624
    v_mfma_f32_16x16x32_bf16 v[108:111], v[28:31], a[44:47], v[108:111]
    s_waitcnt vmcnt(2)
    s_mov_b64 exec, 3
    buffer_atomic_swap v32, v33, s[24:27], s21 offen offset:0 sc1
    s_mov_b64 exec, -1
    ds_read_b64_tr_b16 v[28:29], v5 offset:24576
    s_waitcnt lgkmcnt(3)
    v_mfma_f32_16x16x32_bf16 v[72:75], v[16:19], a[48:51], v[72:75]
    ds_read_b64_tr_b16 v[30:31], v5 offset:26624
    v_mfma_f32_16x16x32_bf16 v[104:107], v[16:19], a[52:55], v[104:107]
    ds_read_b64_tr_b16 v[16:17], v4 offset:28672
    v_mfma_f32_16x16x32_bf16 v[76:79], v[20:23], a[48:51], v[76:79]
    ds_read_b64_tr_b16 v[18:19], v4 offset:30720
    v_cvt_pk_bf16_f32 v64, v64, v65
    v_mfma_f32_16x16x32_bf16 v[108:111], v[20:23], a[52:55], v[108:111]
    ds_read_b64_tr_b16 v[20:21], v5 offset:28672
    s_waitcnt lgkmcnt(3)
    v_mfma_f32_16x16x32_bf16 v[72:75], v[24:27], a[56:59], v[72:75]
    ds_read_b64_tr_b16 v[22:23], v5 offset:30720
    v_cvt_pk_bf16_f32 v65, v66, v67
    v_mfma_f32_16x16x32_bf16 v[104:107], v[24:27], a[60:63], v[104:107]
    v_add_u32 v4, 0xfffe0000, v4
    ds_read_b64_tr_b16 v[24:25], v4 offset:32768
    v_mfma_f32_16x16x32_bf16 v[76:79], v[28:31], a[56:59], v[76:79]
    ds_read_b64_tr_b16 v[26:27], v4 offset:34816
    v_cvt_pk_bf16_f32 v66, v68, v69
    v_mfma_f32_16x16x32_bf16 v[108:111], v[28:31], a[60:63], v[108:111]
    v_add_u32 v5, 0xfffe0000, v5
    ds_read_b64_tr_b16 v[28:29], v5 offset:32768
    s_waitcnt lgkmcnt(3)
    v_mfma_f32_16x16x32_bf16 v[72:75], v[16:19], a[64:67], v[72:75]
    ds_read_b64_tr_b16 v[30:31], v5 offset:34816
    v_cvt_pk_bf16_f32 v67, v70, v71
    v_mfma_f32_16x16x32_bf16 v[104:107], v[16:19], a[68:71], v[104:107]
    ds_read_b64_tr_b16 v[16:17], v4 offset:36864
    v_mfma_f32_16x16x32_bf16 v[76:79], v[20:23], a[64:67], v[76:79]
    ds_read_b64_tr_b16 v[18:19], v4 offset:38912
    buffer_store_dwordx4 v[64:67], v1, s[24:27], s17 offen sc1
    s_add_u32 s17, s17, 2097152
    v_mfma_f32_16x16x32_bf16 v[108:111], v[20:23], a[68:71], v[108:111]
    ds_read_b64_tr_b16 v[20:21], v5 offset:36864
    s_waitcnt lgkmcnt(3)
    v_mfma_f32_16x16x32_bf16 v[72:75], v[24:27], a[72:75], v[72:75]
    ds_read_b64_tr_b16 v[22:23], v5 offset:38912
    v_cvt_pk_bf16_f32 v96, v96, v97
    v_mfma_f32_16x16x32_bf16 v[104:107], v[24:27], a[76:79], v[104:107]
    ds_read_b64_tr_b16 v[24:25], v4 offset:40960
    v_mfma_f32_16x16x32_bf16 v[76:79], v[28:31], a[72:75], v[76:79]
    ds_read_b64_tr_b16 v[26:27], v4 offset:43008
    v_cvt_pk_bf16_f32 v97, v98, v99
    v_mfma_f32_16x16x32_bf16 v[108:111], v[28:31], a[76:79], v[108:111]
    ds_read_b64_tr_b16 v[28:29], v5 offset:40960
    s_waitcnt lgkmcnt(3)
    v_mfma_f32_16x16x32_bf16 v[72:75], v[16:19], a[80:83], v[72:75]
    ds_read_b64_tr_b16 v[30:31], v5 offset:43008
    v_cvt_pk_bf16_f32 v98, v100, v101
    v_mfma_f32_16x16x32_bf16 v[104:107], v[16:19], a[84:87], v[104:107]
    ds_read_b64_tr_b16 v[16:17], v4 offset:45056
    v_mfma_f32_16x16x32_bf16 v[76:79], v[20:23], a[80:83], v[76:79]
    ds_read_b64_tr_b16 v[18:19], v4 offset:47104
    v_cvt_pk_bf16_f32 v99, v102, v103
    v_mfma_f32_16x16x32_bf16 v[108:111], v[20:23], a[84:87], v[108:111]
    ds_read_b64_tr_b16 v[20:21], v5 offset:45056
    s_waitcnt lgkmcnt(3)
    v_mfma_f32_16x16x32_bf16 v[72:75], v[24:27], a[32:35], v[72:75]
    ds_read_b64_tr_b16 v[22:23], v5 offset:47104
    buffer_store_dwordx4 v[96:99], v1, s[24:27], s18 offen sc1
    s_add_u32 s18, s18, 2097152
    v_mfma_f32_16x16x32_bf16 v[104:107], v[24:27], a[36:39], v[104:107]
    v_mfma_f32_16x16x32_bf16 v[76:79], v[28:31], a[32:35], v[76:79]
    v_mfma_f32_16x16x32_bf16 v[108:111], v[28:31], a[36:39], v[108:111]
    s_waitcnt lgkmcnt(0)
    v_mfma_f32_16x16x32_bf16 v[72:75], v[16:19], a[88:91], v[72:75]
    v_mfma_f32_16x16x32_bf16 v[104:107], v[16:19], a[92:95], v[104:107]
    v_mfma_f32_16x16x32_bf16 v[76:79], v[20:23], a[88:91], v[76:79]
    v_mfma_f32_16x16x32_bf16 v[108:111], v[20:23], a[92:95], v[108:111]
    s_nop 4
    v_cvt_pk_bf16_f32 v72, v72, v73
    v_cvt_pk_bf16_f32 v73, v74, v75
    v_cvt_pk_bf16_f32 v74, v76, v77
    v_cvt_pk_bf16_f32 v75, v78, v79
    buffer_store_dwordx4 v[72:75], v1, s[24:27], s17 offen sc1
    v_cvt_pk_bf16_f32 v104, v104, v105
    v_cvt_pk_bf16_f32 v105, v106, v107
    v_cvt_pk_bf16_f32 v106, v108, v109
    v_cvt_pk_bf16_f32 v107, v110, v111
    buffer_store_dwordx4 v[104:107], v1, s[24:27], s18 offen sc1
    s_waitcnt vmcnt(5)
    s_mov_b64 exec, 3
    buffer_atomic_swap v32, v33, s[24:27], s21 offen offset:128 sc1
    s_mov_b64 exec, -1
    s_waitcnt vmcnt(3)
    s_mov_b64 exec, 3
    buffer_atomic_swap v32, v33, s[24:27], s21 offen offset:256 sc1
    s_mov_b64 exec, -1
    s_waitcnt vmcnt(2)
    s_mov_b64 exec, 3
    buffer_atomic_swap v32, v33, s[24:27], s21 offen offset:384 sc1
    s_mov_b64 exec, -1
    s_endpgm
L_codeend:
.section .rodata,"a"
.p2align 6
.amdhsa_kernel standalone__geglu_ffn__sampling_kernel
  .amdhsa_next_free_vgpr 256
  .amdhsa_next_free_sgpr 102
  .amdhsa_accum_offset 112
  .amdhsa_group_segment_fixed_size 0
  .amdhsa_kernarg_size 56
  .amdhsa_user_sgpr_count 2
  .amdhsa_user_sgpr_kernarg_segment_ptr 1
  .amdhsa_system_sgpr_workgroup_id_x 1
  .amdhsa_float_denorm_mode_32 3
.end_amdhsa_kernel
```
